```python
import torch

def _softmax(x, axis=-1):
    return torch.softmax(x, dim=axis)
def _gelu(x):
    return torch.nn.functional.gelu(x, approximate="tanh")
def _silu(x):
    return torch.nn.functional.silu(x)
def _sigmoid(x):
    return torch.sigmoid(x)
def _layernorm(x, axis=-1, eps=1e-5):
    m = x.mean(dim=axis, keepdim=True)
    v = x.var(dim=axis, keepdim=True, unbiased=False)
    return (x - m) / torch.sqrt(v + eps)
def _scatter_add(tgt, idx, src, axis=0):
    return tgt.clone().index_add_(axis, idx, src)
def _segment_sum(src, seg, n):
    out = torch.zeros((n,) + src.shape[1:], dtype=src.dtype)
    return out.index_add_(0, seg, src)
def _pad(x, pw):
    flat = tuple(v for pair in reversed(pw) for v in pair)
    return torch.nn.functional.pad(x, flat)

kernel_name = 'concat_heads__mha_block__ssm_conv_s4d__prompt'

def setup_inputs():

    _w = (lambda a: (lambda t: t.to(torch.bfloat16) if t.is_floating_point() else t)(torch.as_tensor(a)))
    def _A_setup():
        B, S, D, H = 1, 2048, 448, 16
        return {
            "x": _w((lambda *s: torch.randn(*s, dtype=torch.bfloat16) * 0.2)(B, S, D)),
            "wqkv": _w((lambda *s: torch.randn(*s, dtype=torch.bfloat16) * 0.2)(D, 3 * D)),
            "wo": _w((lambda *s: torch.randn(*s, dtype=torch.bfloat16) * 0.05)(D, D)),
        }
    _A_in = _A_setup()

    def _B_setup():
        Bsz, L, D, N = 1, 2048, 448, 256
        return {
            "u": _w((lambda *s: torch.randn(*s, dtype=torch.bfloat16) * 0.05)(Bsz, L, D)),
            "log_A_real": _w((lambda *s: torch.randn(*s, dtype=torch.bfloat16) * 6.4)(D, N) * 0.5),
            "A_imag": _w((lambda *s: torch.randn(*s, dtype=torch.bfloat16) * 0.1)(D, N) * 3.14),
            "C_real": _w((lambda *s: torch.randn(*s, dtype=torch.bfloat16) * 0.4)(D, N) / N ** 0.5),
            "C_imag": _w((lambda *s: torch.randn(*s, dtype=torch.bfloat16) * 0.4)(D, N) / N ** 0.5),
            "log_dt": _w((lambda *s: torch.randn(*s, dtype=torch.bfloat16) * 0.1)(D) * 0.5 - 4.0),
            "D_skip": _w((lambda *s: torch.randn(*s, dtype=torch.bfloat16) * 0.1)(D)),
        }
    _B_in = _B_setup()

    return {
        "A_x": _A_in["x"],
        "A_wqkv": _A_in["wqkv"],
        "A_wo": _A_in["wo"],
        "B_u": _B_in["u"],
        "B_log_A_real": _B_in["log_A_real"],
        "B_A_imag": _B_in["A_imag"],
        "B_C_real": _B_in["C_real"],
        "B_C_imag": _B_in["C_imag"],
        "B_log_dt": _B_in["log_dt"],
        "B_D_skip": _B_in["D_skip"],
    }

def reference(A_x, A_wqkv, A_wo, B_u, B_log_A_real, B_A_imag, B_C_real, B_C_imag, B_log_dt, B_D_skip):
    def _A_ref(x, wqkv, wo):
        B, S, D = x.shape
        H = 16
        Dh = D // H
        qkv = (lambda x, *d: x.permute(*d))((x @ wqkv).reshape(B, S, 3, H, Dh), 2, 0, 3, 1, 4)
        q, k, v = qkv[0], qkv[1], qkv[2]
        scores = torch.einsum("bhqd,bhkd->bhqk", q, k) * (Dh ** -0.5)
        p = _softmax(scores, axis=-1)
        o = torch.einsum("bhqk,bhkd->bhqd", p, v)
        return (lambda x, *d: x.permute(*d))(o, 0, 2, 1, 3).reshape(B, S, D) @ wo

    def _B_ref(u, log_A_real, A_imag, C_real, C_imag, log_dt, D_skip):
        L = u.shape[1]
        dt = torch.exp(log_dt)
        A = -torch.exp(log_A_real) + 1j * A_imag
        C = (C_real + 1j * C_imag) * dt[:, None]
        pos = (lambda x, dt: x.to(dt))(torch.arange(L), log_dt.dtype)
        P = torch.exp((A * dt[:, None])[:, :, None] * pos[None, None, :])
        K = 2.0 * torch.einsum("dn,dnl->dl", C, P).real
        L2 = 2 * L
        u_t = (lambda x, *d: x.permute(*d))(u, 0, 2, 1)
        Kf = (lambda x, *a, **k: torch.fft.rfft(x.float(), *a, **k))(K, L2)
        Uf = (lambda x, *a, **k: torch.fft.rfft(x.float(), *a, **k))(u_t, L2)
        y = (lambda x, *a, **k: torch.fft.irfft(x, *a, **k).to(torch.bfloat16))(Uf * Kf[None, :, :], L2)[:, :, :L]
        y = (lambda x, *d: x.permute(*d))(y, 0, 2, 1)
        return y + u * D_skip[None, None, :]

    a = _A_ref(A_x, A_wqkv, A_wo)
    b = _B_ref(B_u, B_log_A_real, B_A_imag, B_C_real, B_C_imag, B_log_dt, B_D_skip)
    return torch.concatenate([a, b], axis=-1)
```

```asm
; @launch grid=(256,1,1) block=(512,1,1) lds=163840
.amdgcn_target "amdgcn-amd-amdhsa--gfx950"
.text
.globl concat_heads__mha_block__ssm_conv_s4d__prompt_kernel
.p2align 8
.type concat_heads__mha_block__ssm_conv_s4d__prompt_kernel,@function
concat_heads__mha_block__ssm_conv_s4d__prompt_kernel:
  s_cmp_ge_u32 s2, 256
  s_cbranch_scc1 L_end
  s_load_dwordx16 s[64:79], s[0:1], 0
  s_getpc_b64 s[96:97]
  s_bfe_u32 s98, s2, 0x20003
  s_lshl_b32 s98, s98, 13
  v_lshl_add_u32 v2, v0, 4, s98
  v_min_u32 v2, 28416, v2
  global_load_dwordx4 v[192:195], v2, s[96:97]
  s_load_dwordx8 s[80:87], s[0:1], 64
  s_load_dwordx2 s[88:89], s[0:1], 96
  v_lshrrev_b32 v2, 6, v0
  v_and_b32 v1, 63, v0
  v_readfirstlane_b32 s3, v2
  s_and_b32 s22, s2, 7
  s_lshr_b32 s23, s2, 3
  s_and_b32 s27, s22, 1
  s_lshr_b32 s24, s23, 3
  s_lshl_b32 s25, s27, 2
  s_add_u32 s25, s25, s24
  s_and_b32 s26, s23, 7
  s_lshl_b32 s28, s26, 1
  s_add_u32 s28, s28, s27
  s_cmp_eq_u32 s24, 3
  s_cselect_b32 s25, 3, s25
  s_cselect_b32 s26, s28, s26
  s_lshl_b32 s24, s24, 1
  s_add_u32 s24, s24, s26
  s_lshr_b32 s28, s22, 1
  s_lshl_b32 s28, s28, 3
  s_add_u32 s26, s26, s28
  s_mul_i32 s21, s22, 28
  s_add_u32 s21, s21, s23
  s_cmp_ge_u32 s23, 28
  s_cbranch_scc1 L_lite
  s_mov_b32 s95, 0
  v_mov_b32 v250, 146432
  v_mov_b32 v251, 1
  v_lshrrev_b32 v3, 3, v1
  v_and_b32 v4, 7, v1
  s_and_b32 s29, s3, 3
  s_bfe_u32 s63, s3, 0x10001
  s_and_b32 s61, s3, 1
  s_cmp_ge_u32 s3, 4
  s_cbranch_scc1 Q_ssm
  s_sub_u32 s28, s24, 7
  s_cmp_ge_u32 s24, 7
  s_cselect_b32 s27, s28, s24
  s_lshl_b32 s30, s29, 4
  v_add_u32 v5, s30, v3
  v_lshrrev_b32 v6, 1, v5
  v_and_b32 v6, 7, v6
  v_xor_b32 v6, v6, v4
  v_lshlrev_b32 v6, 4, v6
  s_lshl_b32 s30, s26, 6
  v_add_u32 v7, s30, v5
  v_mul_u32_u24 v7, 896, v7
  v_add_u32 v244, v7, v6
  v_xor_b32 v6, 64, v6
  v_add_u32 v245, v7, v6
  v_add_u32 v245, 7168, v245
  v_lshrrev_b32 v6, 1, v5
  v_and_b32 v6, 1, v6
  v_lshlrev_b32 v6, 2, v6
  v_xor_b32 v6, v6, v4
  v_lshlrev_b32 v6, 4, v6
  v_mul_u32_u24 v7, 2688, v5
  v_add_u32 v246, v7, v6
  s_lshl_b32 s30, s25, 7
  v_add_u32 v246, s30, v246
  v_add_u32 v247, 21504, v246
  s_lshl_b32 s32, s29, 11
  s_lshl_b32 s40, s27, 7
  s_mul_i32 s48, s27, 172032
  s_waitcnt lgkmcnt(0)
  s_mov_b32 s8, s64
  s_and_b32 s9, s65, 0xffff
  s_mov_b32 s10, 1835008
  s_mov_b32 s11, 0x20000
  s_mov_b32 s4, s66
  s_and_b32 s5, s67, 0xffff
  s_mov_b32 s6, 1204224
  s_mov_b32 s7, 0x20000
  s_add_u32 m0, s32, 32768
  s_nop 0
  buffer_load_dwordx4 v244, s[8:11], s40 offen  lds
  s_add_u32 m0, s32, 33792
  s_nop 0
  buffer_load_dwordx4 v245, s[8:11], s40 offen  lds
  s_add_u32 m0, s32, 40960
  s_nop 0
  buffer_load_dwordx4 v246, s[4:7], s48 offen lds
  s_add_u32 m0, s32, 41984
  s_nop 0
  buffer_load_dwordx4 v247, s[4:7], s48 offen lds
  s_lshl_b32 s36, s21, 2
  s_add_u32 s82, s82, s36
  s_addc_u32 s83, s83, 0
  s_load_dword s39, s[82:83], 0
  s_add_u32 s27, s27, 1
  s_cmp_eq_u32 s27, 7
  s_cselect_b32 s27, 0, s27
  s_lshl_b32 s41, s27, 7
  s_mul_i32 s49, s27, 172032
  s_add_u32 s27, s27, 1
  s_cmp_eq_u32 s27, 7
  s_cselect_b32 s27, 0, s27
  s_lshl_b32 s42, s27, 7
  s_mul_i32 s50, s27, 172032
  s_add_u32 m0, s32, 49152
  s_nop 0
  buffer_load_dwordx4 v244, s[8:11], s41 offen  lds
  s_add_u32 m0, s32, 50176
  s_nop 0
  buffer_load_dwordx4 v245, s[8:11], s41 offen  lds
  s_add_u32 m0, s32, 57344
  s_nop 0
  buffer_load_dwordx4 v244, s[8:11], s42 offen  lds
  s_add_u32 m0, s32, 58368
  s_nop 0
  buffer_load_dwordx4 v245, s[8:11], s42 offen  lds
  s_add_u32 s27, s27, 1
  s_cmp_eq_u32 s27, 7
  s_cselect_b32 s27, 0, s27
  s_lshl_b32 s43, s27, 7
  s_mul_i32 s51, s27, 172032
  s_add_u32 s27, s27, 1
  s_cmp_eq_u32 s27, 7
  s_cselect_b32 s27, 0, s27
  s_lshl_b32 s44, s27, 7
  s_mul_i32 s52, s27, 172032
  s_add_u32 s27, s27, 1
  s_cmp_eq_u32 s27, 7
  s_cselect_b32 s27, 0, s27
  s_lshl_b32 s45, s27, 7
  s_mul_i32 s53, s27, 172032
  s_add_u32 s27, s27, 1
  s_cmp_eq_u32 s27, 7
  s_cselect_b32 s27, 0, s27
  s_lshl_b32 s46, s27, 7
  s_mul_i32 s54, s27, 172032
  s_mov_b32 s16, s88
  s_and_b32 s17, s89, 0xffff
  s_mov_b32 s18, 11403264
  s_mov_b32 s19, 0x20000
  s_mov_b32 s12, s84
  s_and_b32 s13, s85, 0xffff
  s_mov_b32 s14, 3670016
  s_mov_b32 s15, 0x20000
  v_lshlrev_b32 v6, 3, v0
  v_sub_u32 v6, 2047, v6
  v_mov_b32 v17, 114688
  v_mov_b32 v18, 328
  v_lshlrev_b32 v19, 4, v0
  v_add_u32 v19, 147456, v19
  s_mov_b32 s36, 0
Q_tab:
  v_subrev_u32 v7, 0, v6
  v_subrev_u32 v8, 1, v6
  v_cvt_f32_i32 v2, v7
  v_cvt_f32_i32 v5, v8
  v_cvt_pk_bf16_f32 v2, v2, v5
  v_and_b32 v5, 0xffff0000, v2
  v_lshlrev_b32 v2, 16, v2
  v_cvt_i32_f32 v2, v2
  v_cvt_i32_f32 v5, v5
  v_and_b32 v7, 7, v2
  v_and_b32 v8, 7, v5
  v_ashrrev_i32 v2, 3, v2
  v_ashrrev_i32 v5, 3, v5
  v_mad_u32_u24 v2, v7, v18, v2
  v_mad_u32_u24 v5, v8, v18, v5
  v_lshl_add_u32 v64, v2, 1, v17
  v_lshl_add_u32 v65, v5, 1, v17
  v_subrev_u32 v7, 2, v6
  v_subrev_u32 v8, 3, v6
  v_cvt_f32_i32 v2, v7
  v_cvt_f32_i32 v5, v8
  v_cvt_pk_bf16_f32 v2, v2, v5
  v_and_b32 v5, 0xffff0000, v2
  v_lshlrev_b32 v2, 16, v2
  v_cvt_i32_f32 v2, v2
  v_cvt_i32_f32 v5, v5
  v_and_b32 v7, 7, v2
  v_and_b32 v8, 7, v5
  v_ashrrev_i32 v2, 3, v2
  v_ashrrev_i32 v5, 3, v5
  v_mad_u32_u24 v2, v7, v18, v2
  v_mad_u32_u24 v5, v8, v18, v5
  v_lshl_add_u32 v66, v2, 1, v17
  v_lshl_add_u32 v67, v5, 1, v17
  ds_write_b128 v19, v[64:67]
  v_add_u32 v19, 4096, v19
  v_subrev_u32 v6, 4, v6
  s_add_u32 s36, s36, 1
  s_cmp_lt_u32 s36, 3
  s_cbranch_scc1 Q_tab
  v_and_b32 v17, 15, v1
  s_cmp_eq_u32 s63, 0
  s_mov_b32 exec_lo, 65535
  s_mov_b32 exec_hi, 0
  s_mov_b32 s36, 10485888
  s_cselect_b32 s36, 21495808, s36
  v_mov_b32 v68, s36
  s_mov_b32 s36, 14680256
  s_cselect_b32 s36, 64488080, s36
  v_mov_b32 v70, s36
  s_mov_b32 exec_lo, 4294901760
  s_mov_b32 exec_hi, 0
  s_mov_b32 s36, 18874624
  s_cselect_b32 s36, 107480352, s36
  v_mov_b32 v68, s36
  s_mov_b32 s36, 18874656
  s_cselect_b32 s36, 150472624, s36
  v_mov_b32 v70, s36
  s_mov_b32 exec_lo, 0
  s_mov_b32 exec_hi, 65535
  s_mov_b32 s36, 18874656
  s_cselect_b32 s36, 45088800, s36
  v_mov_b32 v68, s36
  s_mov_b32 s36, 18874656
  s_cselect_b32 s36, 131073344, s36
  v_mov_b32 v70, s36
  s_mov_b32 exec_lo, 0
  s_mov_b32 exec_hi, 4294901760
  s_mov_b32 s36, 18874656
  s_cselect_b32 s36, 90177600, s36
  v_mov_b32 v68, s36
  s_mov_b32 s36, 18874656
  s_cselect_b32 s36, 92274784, s36
  v_mov_b32 v70, s36
  s_mov_b64 exec, -1
  s_lshl_b32 s36, s61, 5
  s_add_u32 s36, s36, 114688
  v_lshl_add_u32 v18, v17, 1, s36
  v_lshrrev_b32 v69, 16, v68
  v_lshrrev_b32 v71, 16, v70
  v_and_b32 v68, 0xffff, v68
  v_and_b32 v70, 0xffff, v70
  v_lshl_add_u32 v68, v68, 1, v18
  v_lshl_add_u32 v69, v69, 1, v18
  v_lshl_add_u32 v70, v70, 1, v18
  v_lshl_add_u32 v71, v71, 1, v18
  ds_write_b128 v19, v[68:71]
  s_and_b32 s27, s3, 1
  s_lshr_b32 s30, s3, 1
  v_and_b32 v3, 31, v1
  v_lshrrev_b32 v4, 5, v1
  s_lshl_b32 s31, s27, 5
  v_add_u32 v5, s31, v3
  v_lshrrev_b32 v6, 1, v5
  v_and_b32 v6, 7, v6
  v_lshlrev_b32 v7, 7, v5
  v_add_u32 v7, 0, v7
  v_add_u32 v56, 0, v4
  v_xor_b32 v56, v56, v6
  v_lshl_add_u32 v56, v56, 4, v7
  v_add_u32 v240, 0x10000, v56
  v_add_u32 v57, 2, v4
  v_xor_b32 v57, v57, v6
  v_lshl_add_u32 v57, v57, 4, v7
  v_add_u32 v241, 0x10000, v57
  v_add_u32 v58, 4, v4
  v_xor_b32 v58, v58, v6
  v_lshl_add_u32 v58, v58, 4, v7
  v_add_u32 v242, 0x10000, v58
  v_add_u32 v59, 6, v4
  v_xor_b32 v59, v59, v6
  v_lshl_add_u32 v59, v59, 4, v7
  v_add_u32 v243, 0x10000, v59
  v_and_b32 v6, 3, v1
  v_lshlrev_b32 v6, 3, v6
  v_bfe_u32 v7, v1, 4, 1
  v_lshl_add_u32 v6, v7, 5, v6
  s_lshl_b32 s31, s30, 6
  v_add_u32 v6, s31, v6
  v_bfe_u32 v7, v1, 3, 1
  v_lshlrev_b32 v7, 6, v7
  v_xor_b32 v6, v6, v7
  v_bfe_u32 v7, v1, 2, 2
  v_lshl_add_u32 v7, v4, 3, v7
  v_lshl_add_u32 v60, v7, 7, v6
  v_add_u32 v248, 0x10000, v60
  s_lshl_b32 s31, s26, 1
  s_add_u32 s31, s31, s27
  s_mul_i32 s31, s31, 28672
  s_lshl_b32 s33, s25, 3
  s_lshl_b32 s34, s30, 2
  s_add_u32 s33, s33, s34
  s_lshl_b32 s34, s33, 9
  s_add_u32 s34, s34, s31
  v_lshlrev_b32 v61, 4, v1
  v_add_u32 v61, s34, v61
  s_lshl_b32 s34, s33, 7
  s_add_u32 s34, s34, s31
  v_mul_u32_u24 v62, 7168, v4
  v_lshl_add_u32 v62, v3, 4, v62
  v_add_u32 v62, s34, v62
  s_mov_b32 s35, 1049335798
  s_lshl_b32 s60, s25, 9
  s_lshl_b32 s61, s26, 4
  s_add_u32 s60, s60, s61
  s_lshl_b32 s61, s3, 2
  s_add_u32 s60, s60, s61
  s_add_u32 s60, s60, 32768
  s_waitcnt lgkmcnt(0)
  s_waitcnt vmcnt(4)
  s_barrier
  s_add_u32 m0, s32, 65536
  s_nop 0
  buffer_load_dwordx4 v246, s[4:7], s49 offen lds
  s_add_u32 m0, s32, 66560
  s_nop 0
  buffer_load_dwordx4 v247, s[4:7], s49 offen lds
  ds_read_b128 v[64:67], v56 offset:32768
  ds_read_b128 v[68:71], v57 offset:32768
  ds_read_b128 v[72:75], v58 offset:32768
  ds_read_b128 v[76:79], v59 offset:32768
  ds_read_b64_tr_b16 v[8:9], v60 offset:40960
  ds_read_b64_tr_b16 v[10:11], v60 offset:41472
  s_add_u32 m0, s32, 73728
  s_nop 0
  buffer_load_dwordx4 v246, s[4:7], s50 offen lds
  s_add_u32 m0, s32, 74752
  s_nop 0
  buffer_load_dwordx4 v247, s[4:7], s50 offen lds
  ds_read_b64_tr_b16 v[12:13], v60 offset:43008
  ds_read_b64_tr_b16 v[14:15], v60 offset:43520
  ds_read_b64_tr_b16 v[16:17], v60 offset:45056
  ds_read_b64_tr_b16 v[18:19], v60 offset:45568
  ds_read_b64_tr_b16 v[20:21], v60 offset:47104
  ds_read_b64_tr_b16 v[22:23], v60 offset:47616
  s_add_u32 m0, s32, 81920
  s_nop 0
  buffer_load_dwordx4 v244, s[8:11], s43 offen  lds
  s_add_u32 m0, s32, 82944
  s_nop 0
  buffer_load_dwordx4 v245, s[8:11], s43 offen  lds
  s_add_u32 m0, s32, 90112
  s_nop 0
  buffer_load_dwordx4 v246, s[4:7], s51 offen lds
  s_add_u32 m0, s32, 91136
  s_nop 0
  buffer_load_dwordx4 v247, s[4:7], s51 offen lds
  s_waitcnt lgkmcnt(0)
  s_waitcnt vmcnt(8)
  s_barrier
  v_mfma_f32_32x32x16_bf16 v[208:223], v[8:11], v[64:67], 0
  s_add_u32 m0, s32, 98304
  s_nop 0
  buffer_load_dwordx4 v244, s[8:11], s44 offen  lds
  s_add_u32 m0, s32, 99328
  s_nop 0
  buffer_load_dwordx4 v245, s[8:11], s44 offen  lds
  ds_read_b128 v[80:83], v56 offset:49152
  ds_read_b128 v[84:87], v57 offset:49152
  ds_read_b128 v[88:91], v58 offset:49152
  ds_read_b128 v[92:95], v59 offset:49152
  v_mfma_f32_32x32x16_bf16 v[208:223], v[12:15], v[68:71], v[208:223]
  s_add_u32 m0, s32, 106496
  s_nop 0
  buffer_load_dwordx4 v246, s[4:7], s52 offen lds
  s_add_u32 m0, s32, 107520
  s_nop 0
  buffer_load_dwordx4 v247, s[4:7], s52 offen lds
  ds_read_b128 v[96:99], v56 offset:57344
  ds_read_b128 v[100:103], v57 offset:57344
  ds_read_b128 v[104:107], v58 offset:57344
  ds_read_b128 v[108:111], v59 offset:57344
  v_mfma_f32_32x32x16_bf16 v[208:223], v[16:19], v[72:75], v[208:223]
  s_add_u32 m0, s32, 114688
  s_nop 0
  buffer_load_dwordx4 v244, s[8:11], s45 offen  lds
  s_add_u32 m0, s32, 115712
  s_nop 0
  buffer_load_dwordx4 v245, s[8:11], s45 offen  lds
  v_mfma_f32_32x32x16_bf16 v[208:223], v[20:23], v[76:79], v[208:223]
  s_add_u32 m0, s32, 122880
  s_nop 0
  buffer_load_dwordx4 v246, s[4:7], s53 offen lds
  s_add_u32 m0, s32, 123904
  s_nop 0
  buffer_load_dwordx4 v247, s[4:7], s53 offen lds
  s_waitcnt lgkmcnt(0)
  s_waitcnt vmcnt(12)
  s_barrier
  s_add_u32 m0, s32, 0
  s_nop 0
  buffer_load_dwordx4 v244, s[8:11], s46 offen  lds
  ds_read_b64_tr_b16 v[8:9], v248 offset:0
  ds_read_b64_tr_b16 v[10:11], v248 offset:512
  ds_read_b64_tr_b16 v[12:13], v248 offset:2048
  ds_read_b64_tr_b16 v[14:15], v248 offset:2560
  ds_read_b64_tr_b16 v[16:17], v248 offset:4096
  ds_read_b64_tr_b16 v[18:19], v248 offset:4608
  ds_read_b64_tr_b16 v[20:21], v248 offset:6144
  ds_read_b64_tr_b16 v[22:23], v248 offset:6656
  s_add_u32 m0, s32, 1024
  s_nop 0
  buffer_load_dwordx4 v245, s[8:11], s46 offen  lds
  ds_read_b64_tr_b16 v[24:25], v248 offset:8192
  ds_read_b64_tr_b16 v[26:27], v248 offset:8704
  ds_read_b64_tr_b16 v[28:29], v248 offset:10240
  ds_read_b64_tr_b16 v[30:31], v248 offset:10752
  ds_read_b64_tr_b16 v[32:33], v248 offset:12288
  ds_read_b64_tr_b16 v[34:35], v248 offset:12800
  ds_read_b64_tr_b16 v[36:37], v248 offset:14336
  ds_read_b64_tr_b16 v[38:39], v248 offset:14848
  s_add_u32 m0, s32, 8192
  s_nop 0
  buffer_load_dwordx4 v246, s[4:7], s54 offen lds
  s_add_u32 m0, s32, 9216
  s_nop 0
  buffer_load_dwordx4 v247, s[4:7], s54 offen lds
  s_waitcnt lgkmcnt(0)
  s_waitcnt vmcnt(12)
  s_barrier
  v_mfma_f32_32x32x16_bf16 v[208:223], v[8:11], v[80:83], v[208:223]
  s_add_u32 m0, s32, 16384
  s_add_u32 s37, s48, 896
  buffer_load_dwordx4 v246, s[4:7], s37 offen lds
  ds_read_b128 v[112:115], v240 offset:16384
  ds_read_b128 v[116:119], v241 offset:16384
  v_mfma_f32_32x32x16_bf16 v[208:223], v[12:15], v[84:87], v[208:223]
  ds_read_b128 v[120:123], v242 offset:16384
  ds_read_b128 v[124:127], v243 offset:16384
  v_mfma_f32_32x32x16_bf16 v[208:223], v[16:19], v[88:91], v[208:223]
  s_add_u32 m0, s32, 17408
  s_nop 0
  buffer_load_dwordx4 v247, s[4:7], s37 offen lds
  ds_read_b64_tr_b16 v[224:225], v248 offset:24576
  ds_read_b64_tr_b16 v[226:227], v248 offset:25088
  v_mfma_f32_32x32x16_bf16 v[208:223], v[20:23], v[92:95], v[208:223]
  ds_read_b64_tr_b16 v[228:229], v248 offset:26624
  ds_read_b64_tr_b16 v[230:231], v248 offset:27136
  v_mfma_f32_32x32x16_bf16 v[208:223], v[24:27], v[96:99], v[208:223]
  s_add_u32 m0, s32, 24576
  s_add_u32 s37, s49, 896
  buffer_load_dwordx4 v246, s[4:7], s37 offen lds
  ds_read_b64_tr_b16 v[232:233], v248 offset:28672
  ds_read_b64_tr_b16 v[234:235], v248 offset:29184
  v_mfma_f32_32x32x16_bf16 v[208:223], v[28:31], v[100:103], v[208:223]
  ds_read_b64_tr_b16 v[236:237], v248 offset:30720
  ds_read_b64_tr_b16 v[238:239], v248 offset:31232
  v_mfma_f32_32x32x16_bf16 v[208:223], v[32:35], v[104:107], v[208:223]
  s_add_u32 m0, s32, 25600
  s_nop 0
  buffer_load_dwordx4 v247, s[4:7], s37 offen lds
  v_mfma_f32_32x32x16_bf16 v[208:223], v[36:39], v[108:111], v[208:223]
  s_waitcnt lgkmcnt(0)
  s_waitcnt vmcnt(12)
  s_barrier
  v_mfma_f32_32x32x16_bf16 v[208:223], v[224:227], v[112:115], v[208:223]
  s_add_u32 m0, s32, 32768
  s_add_u32 s37, s50, 896
  buffer_load_dwordx4 v246, s[4:7], s37 offen lds
  ds_read_b128 v[128:131], v240 offset:32768
  ds_read_b128 v[132:135], v241 offset:32768
  ds_read_b128 v[136:139], v242 offset:32768
  ds_read_b128 v[140:143], v243 offset:32768
  ds_read_b64_tr_b16 v[8:9], v248 offset:40960
  ds_read_b64_tr_b16 v[10:11], v248 offset:41472
  v_mfma_f32_32x32x16_bf16 v[208:223], v[228:231], v[116:119], v[208:223]
  s_add_u32 m0, s32, 33792
  s_nop 0
  buffer_load_dwordx4 v247, s[4:7], s37 offen lds
  ds_read_b64_tr_b16 v[12:13], v248 offset:43008
  ds_read_b64_tr_b16 v[14:15], v248 offset:43520
  ds_read_b64_tr_b16 v[16:17], v248 offset:45056
  ds_read_b64_tr_b16 v[18:19], v248 offset:45568
  ds_read_b64_tr_b16 v[20:21], v248 offset:47104
  ds_read_b64_tr_b16 v[22:23], v248 offset:47616
  v_mfma_f32_32x32x16_bf16 v[208:223], v[232:235], v[120:123], v[208:223]
  s_add_u32 m0, s32, 40960
  s_add_u32 s37, s51, 896
  buffer_load_dwordx4 v246, s[4:7], s37 offen lds
  v_mfma_f32_32x32x16_bf16 v[208:223], v[236:239], v[124:127], v[208:223]
  s_add_u32 m0, s32, 41984
  s_nop 0
  buffer_load_dwordx4 v247, s[4:7], s37 offen lds
  s_waitcnt lgkmcnt(0)
  s_waitcnt vmcnt(12)
  s_barrier
  v_mfma_f32_32x32x16_bf16 v[208:223], v[8:11], v[128:131], v[208:223]
  s_add_u32 m0, s32, 49152
  s_add_u32 s37, s52, 896
  buffer_load_dwordx4 v246, s[4:7], s37 offen lds
  ds_read_b128 v[144:147], v240 offset:49152
  ds_read_b128 v[148:151], v241 offset:49152
  ds_read_b128 v[152:155], v242 offset:49152
  ds_read_b128 v[156:159], v243 offset:49152
  ds_read_b64_tr_b16 v[224:225], v248 offset:57344
  ds_read_b64_tr_b16 v[226:227], v248 offset:57856
  v_mfma_f32_32x32x16_bf16 v[208:223], v[12:15], v[132:135], v[208:223]
  s_add_u32 m0, s32, 50176
  s_nop 0
  buffer_load_dwordx4 v247, s[4:7], s37 offen lds
  ds_read_b64_tr_b16 v[228:229], v248 offset:59392
  ds_read_b64_tr_b16 v[230:231], v248 offset:59904
  ds_read_b64_tr_b16 v[232:233], v248 offset:61440
  ds_read_b64_tr_b16 v[234:235], v248 offset:61952
  ds_read_b64_tr_b16 v[236:237], v248 offset:63488
  ds_read_b64_tr_b16 v[238:239], v248 offset:64000
  v_mfma_f32_32x32x16_bf16 v[208:223], v[16:19], v[136:139], v[208:223]
  s_add_u32 m0, s32, 57344
  s_add_u32 s37, s53, 896
  buffer_load_dwordx4 v246, s[4:7], s37 offen lds
  v_mfma_f32_32x32x16_bf16 v[208:223], v[20:23], v[140:143], v[208:223]
  s_add_u32 m0, s32, 58368
  s_nop 0
  buffer_load_dwordx4 v247, s[4:7], s37 offen lds
  s_waitcnt lgkmcnt(0)
  s_waitcnt vmcnt(12)
  s_barrier
  v_mfma_f32_32x32x16_bf16 v[208:223], v[224:227], v[144:147], v[208:223]
  s_add_u32 m0, s32, 65536
  s_add_u32 s37, s54, 896
  buffer_load_dwordx4 v246, s[4:7], s37 offen lds
  ds_read_b128 v[160:163], v56 offset:0
  ds_read_b128 v[164:167], v57 offset:0
  ds_read_b128 v[168:171], v58 offset:0
  ds_read_b128 v[172:175], v59 offset:0
  ds_read_b64_tr_b16 v[8:9], v60 offset:8192
  ds_read_b64_tr_b16 v[10:11], v60 offset:8704
  v_mfma_f32_32x32x16_bf16 v[208:223], v[228:231], v[148:151], v[208:223]
  s_add_u32 m0, s32, 66560
  s_nop 0
  buffer_load_dwordx4 v247, s[4:7], s37 offen lds
  ds_read_b64_tr_b16 v[12:13], v60 offset:10240
  ds_read_b64_tr_b16 v[14:15], v60 offset:10752
  ds_read_b64_tr_b16 v[16:17], v60 offset:12288
  ds_read_b64_tr_b16 v[18:19], v60 offset:12800
  ds_read_b64_tr_b16 v[20:21], v60 offset:14336
  ds_read_b64_tr_b16 v[22:23], v60 offset:14848
  v_mfma_f32_32x32x16_bf16 v[208:223], v[232:235], v[152:155], v[208:223]
  s_add_u32 m0, s32, 73728
  s_add_u32 s37, s48, 1792
  buffer_load_dwordx4 v246, s[4:7], s37 offen lds
  v_mfma_f32_32x32x16_bf16 v[208:223], v[236:239], v[156:159], v[208:223]
  s_add_u32 m0, s32, 74752
  s_nop 0
  buffer_load_dwordx4 v247, s[4:7], s37 offen lds
  s_waitcnt lgkmcnt(0)
  s_waitcnt vmcnt(12)
  s_barrier
  v_mfma_f32_32x32x16_bf16 v[208:223], v[8:11], v[160:163], v[208:223]
  s_add_u32 m0, s32, 81920
  s_add_u32 s37, s49, 1792
  buffer_load_dwordx4 v246, s[4:7], s37 offen lds
  ds_read_b64_tr_b16 v[224:225], v60 offset:16384
  ds_read_b64_tr_b16 v[226:227], v60 offset:16896
  ds_read_b64_tr_b16 v[228:229], v60 offset:18432
  ds_read_b64_tr_b16 v[230:231], v60 offset:18944
  ds_read_b64_tr_b16 v[232:233], v60 offset:20480
  ds_read_b64_tr_b16 v[234:235], v60 offset:20992
  ds_read_b64_tr_b16 v[236:237], v60 offset:22528
  ds_read_b64_tr_b16 v[238:239], v60 offset:23040
  v_mfma_f32_32x32x16_bf16 v[208:223], v[12:15], v[164:167], v[208:223]
  s_add_u32 m0, s32, 82944
  s_nop 0
  buffer_load_dwordx4 v247, s[4:7], s37 offen lds
  ds_read_b64_tr_b16 v[40:41], v60 offset:24576
  ds_read_b64_tr_b16 v[42:43], v60 offset:25088
  ds_read_b64_tr_b16 v[44:45], v60 offset:26624
  ds_read_b64_tr_b16 v[46:47], v60 offset:27136
  ds_read_b64_tr_b16 v[48:49], v60 offset:28672
  ds_read_b64_tr_b16 v[50:51], v60 offset:29184
  ds_read_b64_tr_b16 v[52:53], v60 offset:30720
  ds_read_b64_tr_b16 v[54:55], v60 offset:31232
  v_mfma_f32_32x32x16_bf16 v[208:223], v[16:19], v[168:171], v[208:223]
  s_add_u32 m0, s32, 90112
  s_add_u32 s37, s50, 1792
  buffer_load_dwordx4 v246, s[4:7], s37 offen lds
  v_mfma_f32_32x32x16_bf16 v[208:223], v[20:23], v[172:175], v[208:223]
  s_add_u32 m0, s32, 91136
  s_nop 0
  buffer_load_dwordx4 v247, s[4:7], s37 offen lds
  s_waitcnt lgkmcnt(0)
  s_waitcnt vmcnt(12)
  s_barrier
  v_mfma_f32_32x32x16_bf16 v[176:191], v[224:227], v[64:67], 0
  s_add_u32 m0, s32, 98304
  s_add_u32 s37, s51, 1792
  buffer_load_dwordx4 v246, s[4:7], s37 offen lds
  ds_read_b64_tr_b16 v[8:9], v60 offset:32768
  ds_read_b64_tr_b16 v[10:11], v60 offset:33280
  ds_read_b64_tr_b16 v[12:13], v60 offset:34816
  v_mfma_f32_32x32x16_bf16 v[176:191], v[228:231], v[68:71], v[176:191]
  ds_read_b64_tr_b16 v[14:15], v60 offset:35328
  ds_read_b64_tr_b16 v[16:17], v60 offset:36864
  ds_read_b64_tr_b16 v[18:19], v60 offset:37376
  v_mfma_f32_32x32x16_bf16 v[176:191], v[232:235], v[72:75], v[176:191]
  s_add_u32 m0, s32, 99328
  s_nop 0
  buffer_load_dwordx4 v247, s[4:7], s37 offen lds
  ds_read_b64_tr_b16 v[20:21], v60 offset:38912
  ds_read_b64_tr_b16 v[22:23], v60 offset:39424
  ds_read_b64_tr_b16 v[24:25], v60 offset:40960
  v_mul_f32 v208, s35, v208
  v_mul_f32 v209, s35, v209
  v_mul_f32 v210, s35, v210
  v_mfma_f32_32x32x16_bf16 v[176:191], v[236:239], v[76:79], v[176:191]
  ds_read_b64_tr_b16 v[26:27], v60 offset:41472
  ds_read_b64_tr_b16 v[28:29], v60 offset:43008
  ds_read_b64_tr_b16 v[30:31], v60 offset:43520
  v_mul_f32 v211, s35, v211
  v_mul_f32 v212, s35, v212
  v_mul_f32 v213, s35, v213
  v_mfma_f32_32x32x16_bf16 v[176:191], v[40:43], v[80:83], v[176:191]
  s_add_u32 m0, s32, 106496
  s_add_u32 s37, s52, 1792
  buffer_load_dwordx4 v246, s[4:7], s37 offen lds
  ds_read_b64_tr_b16 v[32:33], v60 offset:45056
  ds_read_b64_tr_b16 v[34:35], v60 offset:45568
  ds_read_b64_tr_b16 v[36:37], v60 offset:47104
  v_mul_f32 v214, s35, v214
  v_mul_f32 v215, s35, v215
  v_mul_f32 v216, s35, v216
  v_mfma_f32_32x32x16_bf16 v[176:191], v[44:47], v[84:87], v[176:191]
  ds_read_b64_tr_b16 v[38:39], v60 offset:47616
  v_mul_f32 v217, s35, v217
  v_mul_f32 v218, s35, v218
  v_mul_f32 v219, s35, v219
  v_mfma_f32_32x32x16_bf16 v[176:191], v[48:51], v[88:91], v[176:191]
  s_add_u32 m0, s32, 107520
  s_nop 0
  buffer_load_dwordx4 v247, s[4:7], s37 offen lds
  v_mul_f32 v220, s35, v220
  v_mul_f32 v221, s35, v221
  v_mul_f32 v222, s35, v222
  v_mfma_f32_32x32x16_bf16 v[176:191], v[52:55], v[92:95], v[176:191]
  v_mul_f32 v223, s35, v223
  s_waitcnt lgkmcnt(0)
  s_waitcnt vmcnt(12)
  s_barrier
  v_mfma_f32_32x32x16_bf16 v[176:191], v[8:11], v[96:99], v[176:191]
  s_add_u32 m0, s32, 114688
  s_add_u32 s37, s53, 1792
  buffer_load_dwordx4 v246, s[4:7], s37 offen lds
  ds_read_b64_tr_b16 v[224:225], v60 offset:49152
  ds_read_b64_tr_b16 v[226:227], v60 offset:49664
  ds_read_b64_tr_b16 v[228:229], v60 offset:51200
  v_mfma_f32_32x32x16_bf16 v[176:191], v[12:15], v[100:103], v[176:191]
  ds_read_b64_tr_b16 v[230:231], v60 offset:51712
  ds_read_b64_tr_b16 v[232:233], v60 offset:53248
  ds_read_b64_tr_b16 v[234:235], v60 offset:53760
  v_mfma_f32_32x32x16_bf16 v[176:191], v[16:19], v[104:107], v[176:191]
  s_add_u32 m0, s32, 115712
  s_nop 0
  buffer_load_dwordx4 v247, s[4:7], s37 offen lds
  ds_read_b64_tr_b16 v[236:237], v60 offset:55296
  ds_read_b64_tr_b16 v[238:239], v60 offset:55808
  ds_read_b64_tr_b16 v[40:41], v60 offset:57344
  v_cvt_pk_bf16_f32 v208, v208, v209
  v_cvt_pk_bf16_f32 v209, v210, v211
  v_mfma_f32_32x32x16_bf16 v[176:191], v[20:23], v[108:111], v[176:191]
  ds_read_b64_tr_b16 v[42:43], v60 offset:57856
  ds_read_b64_tr_b16 v[44:45], v60 offset:59392
  ds_read_b64_tr_b16 v[46:47], v60 offset:59904
  v_cvt_pk_bf16_f32 v210, v212, v213
  v_cvt_pk_bf16_f32 v211, v214, v215
  v_mfma_f32_32x32x16_bf16 v[176:191], v[24:27], v[112:115], v[176:191]
  s_add_u32 m0, s32, 122880
  s_add_u32 s37, s54, 1792
  buffer_load_dwordx4 v246, s[4:7], s37 offen lds
  ds_read_b64_tr_b16 v[48:49], v60 offset:61440
  ds_read_b64_tr_b16 v[50:51], v60 offset:61952
  ds_read_b64_tr_b16 v[52:53], v60 offset:63488
  v_cvt_pk_bf16_f32 v212, v216, v217
  v_cvt_pk_bf16_f32 v213, v218, v219
  v_mfma_f32_32x32x16_bf16 v[176:191], v[28:31], v[116:119], v[176:191]
  ds_read_b64_tr_b16 v[54:55], v60 offset:64000
  v_cvt_pk_bf16_f32 v214, v220, v221
  v_cvt_pk_bf16_f32 v215, v222, v223
  v_mfma_f32_32x32x16_bf16 v[176:191], v[32:35], v[120:123], v[176:191]
  s_add_u32 m0, s32, 123904
  s_nop 0
  buffer_load_dwordx4 v247, s[4:7], s37 offen lds
  v_permlane32_swap_b32 v208, v210
  v_permlane32_swap_b32 v209, v211
  v_mfma_f32_32x32x16_bf16 v[176:191], v[36:39], v[124:127], v[176:191]
  v_permlane32_swap_b32 v212, v214
  v_permlane32_swap_b32 v213, v215
  s_waitcnt lgkmcnt(0)
  s_waitcnt vmcnt(12)
  s_barrier
  v_mfma_f32_32x32x16_bf16 v[176:191], v[224:227], v[128:131], v[176:191]
  ds_read_b64_tr_b16 v[8:9], v248 offset:0
  ds_read_b64_tr_b16 v[10:11], v248 offset:512
  ds_read_b64_tr_b16 v[12:13], v248 offset:2048
  v_mfma_f32_32x32x16_bf16 v[176:191], v[228:231], v[132:135], v[176:191]
  ds_read_b64_tr_b16 v[14:15], v248 offset:2560
  ds_read_b64_tr_b16 v[16:17], v248 offset:4096
  ds_read_b64_tr_b16 v[18:19], v248 offset:4608
  v_mfma_f32_32x32x16_bf16 v[176:191], v[232:235], v[136:139], v[176:191]
  ds_read_b64_tr_b16 v[20:21], v248 offset:6144
  ds_read_b64_tr_b16 v[22:23], v248 offset:6656
  ds_read_b64_tr_b16 v[24:25], v248 offset:8192
  s_mov_b32 s36, 131072
  v_mfma_f32_32x32x16_bf16 v[176:191], v[236:239], v[140:143], v[176:191]
  ds_read_b64_tr_b16 v[26:27], v248 offset:8704
  ds_read_b64_tr_b16 v[28:29], v248 offset:10240
  ds_read_b64_tr_b16 v[30:31], v248 offset:10752
  buffer_store_dwordx4 v[208:211], v61, s[16:19], s36 offen sc1
  v_mfma_f32_32x32x16_bf16 v[176:191], v[40:43], v[144:147], v[176:191]
  ds_read_b64_tr_b16 v[32:33], v248 offset:12288
  ds_read_b64_tr_b16 v[34:35], v248 offset:12800
  ds_read_b64_tr_b16 v[36:37], v248 offset:14336
  buffer_store_dwordx4 v[212:215], v61, s[16:19], s36 offen offset:1024 sc1
  v_mfma_f32_32x32x16_bf16 v[176:191], v[44:47], v[148:151], v[176:191]
  ds_read_b64_tr_b16 v[38:39], v248 offset:14848
  v_mfma_f32_32x32x16_bf16 v[176:191], v[48:51], v[152:155], v[176:191]
  v_mfma_f32_32x32x16_bf16 v[176:191], v[52:55], v[156:159], v[176:191]
  s_waitcnt lgkmcnt(0)
  s_waitcnt vmcnt(10)
  s_barrier
  v_mfma_f32_32x32x16_bf16 v[176:191], v[8:11], v[160:163], v[176:191]
  ds_read_b64_tr_b16 v[224:225], v248 offset:16384
  ds_read_b64_tr_b16 v[226:227], v248 offset:16896
  ds_read_b64_tr_b16 v[228:229], v248 offset:18432
  v_mfma_f32_32x32x16_bf16 v[176:191], v[12:15], v[164:167], v[176:191]
  ds_read_b64_tr_b16 v[230:231], v248 offset:18944
  ds_read_b64_tr_b16 v[232:233], v248 offset:20480
  ds_read_b64_tr_b16 v[234:235], v248 offset:20992
  v_mfma_f32_32x32x16_bf16 v[176:191], v[16:19], v[168:171], v[176:191]
  ds_read_b64_tr_b16 v[236:237], v248 offset:22528
  ds_read_b64_tr_b16 v[238:239], v248 offset:23040
  ds_read_b64_tr_b16 v[40:41], v248 offset:24576
  v_mfma_f32_32x32x16_bf16 v[176:191], v[20:23], v[172:175], v[176:191]
  ds_read_b64_tr_b16 v[42:43], v248 offset:25088
  ds_read_b64_tr_b16 v[44:45], v248 offset:26624
  ds_read_b64_tr_b16 v[46:47], v248 offset:27136
  v_mfma_f32_32x32x16_bf16 v[192:207], v[64:67], v[24:27], 0
  ds_read_b64_tr_b16 v[48:49], v248 offset:28672
  ds_read_b64_tr_b16 v[50:51], v248 offset:29184
  ds_read_b64_tr_b16 v[52:53], v248 offset:30720
  v_mfma_f32_32x32x16_bf16 v[192:207], v[68:71], v[28:31], v[192:207]
  ds_read_b64_tr_b16 v[54:55], v248 offset:31232
  v_mfma_f32_32x32x16_bf16 v[192:207], v[72:75], v[32:35], v[192:207]
  v_mfma_f32_32x32x16_bf16 v[192:207], v[76:79], v[36:39], v[192:207]
  s_waitcnt lgkmcnt(0)
  s_waitcnt vmcnt(6)
  s_barrier
  v_mfma_f32_32x32x16_bf16 v[192:207], v[80:83], v[224:227], v[192:207]
  ds_read_b64_tr_b16 v[8:9], v248 offset:32768
  ds_read_b64_tr_b16 v[10:11], v248 offset:33280
  ds_read_b64_tr_b16 v[12:13], v248 offset:34816
  v_mfma_f32_32x32x16_bf16 v[192:207], v[84:87], v[228:231], v[192:207]
  ds_read_b64_tr_b16 v[14:15], v248 offset:35328
  ds_read_b64_tr_b16 v[16:17], v248 offset:36864
  ds_read_b64_tr_b16 v[18:19], v248 offset:37376
  v_mfma_f32_32x32x16_bf16 v[192:207], v[88:91], v[232:235], v[192:207]
  ds_read_b64_tr_b16 v[20:21], v248 offset:38912
  ds_read_b64_tr_b16 v[22:23], v248 offset:39424
  ds_read_b64_tr_b16 v[24:25], v248 offset:40960
  v_cvt_pk_bf16_f32 v176, v176, v177
  v_cvt_pk_bf16_f32 v177, v178, v179
  v_cvt_pk_bf16_f32 v178, v180, v181
  v_mfma_f32_32x32x16_bf16 v[192:207], v[92:95], v[236:239], v[192:207]
  ds_read_b64_tr_b16 v[26:27], v248 offset:41472
  ds_read_b64_tr_b16 v[28:29], v248 offset:43008
  ds_read_b64_tr_b16 v[30:31], v248 offset:43520
  v_cvt_pk_bf16_f32 v179, v182, v183
  v_cvt_pk_bf16_f32 v180, v184, v185
  v_cvt_pk_bf16_f32 v181, v186, v187
  v_mfma_f32_32x32x16_bf16 v[192:207], v[96:99], v[40:43], v[192:207]
  ds_read_b64_tr_b16 v[32:33], v248 offset:45056
  ds_read_b64_tr_b16 v[34:35], v248 offset:45568
  ds_read_b64_tr_b16 v[36:37], v248 offset:47104
  v_cvt_pk_bf16_f32 v182, v188, v189
  v_cvt_pk_bf16_f32 v183, v190, v191
  v_permlane32_swap_b32 v176, v178
  v_mfma_f32_32x32x16_bf16 v[192:207], v[100:103], v[44:47], v[192:207]
  ds_read_b64_tr_b16 v[38:39], v248 offset:47616
  v_permlane32_swap_b32 v177, v179
  v_permlane32_swap_b32 v180, v182
  v_permlane32_swap_b32 v181, v183
  v_mfma_f32_32x32x16_bf16 v[192:207], v[104:107], v[48:51], v[192:207]
  s_mov_b32 s36, 1966080
  buffer_store_dwordx4 v[176:179], v61, s[16:19], s36 offen sc1
  buffer_store_dwordx4 v[180:183], v61, s[16:19], s36 offen offset:1024 sc1
  v_mfma_f32_32x32x16_bf16 v[192:207], v[108:111], v[52:55], v[192:207]
  s_waitcnt lgkmcnt(0)
  s_waitcnt vmcnt(4)
  s_barrier
  v_mfma_f32_32x32x16_bf16 v[192:207], v[112:115], v[8:11], v[192:207]
  ds_read_b64_tr_b16 v[224:225], v248 offset:49152
  ds_read_b64_tr_b16 v[226:227], v248 offset:49664
  ds_read_b64_tr_b16 v[228:229], v248 offset:51200
  v_mfma_f32_32x32x16_bf16 v[192:207], v[116:119], v[12:15], v[192:207]
  ds_read_b64_tr_b16 v[230:231], v248 offset:51712
  ds_read_b64_tr_b16 v[232:233], v248 offset:53248
  ds_read_b64_tr_b16 v[234:235], v248 offset:53760
  v_mfma_f32_32x32x16_bf16 v[192:207], v[120:123], v[16:19], v[192:207]
  ds_read_b64_tr_b16 v[236:237], v248 offset:55296
  ds_read_b64_tr_b16 v[238:239], v248 offset:55808
  ds_read_b64_tr_b16 v[40:41], v248 offset:57344
  v_mfma_f32_32x32x16_bf16 v[192:207], v[124:127], v[20:23], v[192:207]
  ds_read_b64_tr_b16 v[42:43], v248 offset:57856
  ds_read_b64_tr_b16 v[44:45], v248 offset:59392
  ds_read_b64_tr_b16 v[46:47], v248 offset:59904
  v_mfma_f32_32x32x16_bf16 v[192:207], v[128:131], v[24:27], v[192:207]
  ds_read_b64_tr_b16 v[48:49], v248 offset:61440
  ds_read_b64_tr_b16 v[50:51], v248 offset:61952
  ds_read_b64_tr_b16 v[52:53], v248 offset:63488
  v_mfma_f32_32x32x16_bf16 v[192:207], v[132:135], v[28:31], v[192:207]
  ds_read_b64_tr_b16 v[54:55], v248 offset:64000
  v_mfma_f32_32x32x16_bf16 v[192:207], v[136:139], v[32:35], v[192:207]
  v_mfma_f32_32x32x16_bf16 v[192:207], v[140:143], v[36:39], v[192:207]
  s_waitcnt lgkmcnt(0)
  v_mfma_f32_32x32x16_bf16 v[192:207], v[144:147], v[224:227], v[192:207]
  v_mfma_f32_32x32x16_bf16 v[192:207], v[148:151], v[228:231], v[192:207]
  v_mfma_f32_32x32x16_bf16 v[192:207], v[152:155], v[232:235], v[192:207]
  v_mfma_f32_32x32x16_bf16 v[192:207], v[156:159], v[236:239], v[192:207]
  v_mfma_f32_32x32x16_bf16 v[192:207], v[160:163], v[40:43], v[192:207]
  v_mfma_f32_32x32x16_bf16 v[192:207], v[164:167], v[44:47], v[192:207]
  v_mfma_f32_32x32x16_bf16 v[192:207], v[168:171], v[48:51], v[192:207]
  v_mfma_f32_32x32x16_bf16 v[192:207], v[172:175], v[52:55], v[192:207]
  s_nop 11
  v_cvt_pk_bf16_f32 v192, v192, v193
  v_cvt_pk_bf16_f32 v193, v194, v195
  v_cvt_pk_bf16_f32 v194, v196, v197
  v_cvt_pk_bf16_f32 v195, v198, v199
  v_cvt_pk_bf16_f32 v196, v200, v201
  v_cvt_pk_bf16_f32 v197, v202, v203
  v_cvt_pk_bf16_f32 v198, v204, v205
  v_cvt_pk_bf16_f32 v199, v206, v207
  s_mov_b32 s36, 3801088
  buffer_store_dwordx4 v[192:195], v62, s[16:19], s36 offen sc1
  s_mov_b32 s36, 3815424
  buffer_store_dwordx4 v[196:199], v62, s[16:19], s36 offen sc1
  v_and_b32 v14, 255, v0
  v_lshlrev_b32 v249, 4, v14
  v_add_u32 v15, 147456, v249
  ds_read_b128 v[224:227], v15 offset:0
  ds_read_b128 v[228:231], v15 offset:4096
  ds_read_b128 v[232:235], v15 offset:8192
  ds_read_b128 v[22:25], v15 offset:12288
  v_and_b32 v20, 15, v1
  v_lshrrev_b32 v21, 4, v1
  v_mul_u32_u24 v20, 1056, v20
  v_lshl_add_u32 v20, v21, 4, v20
  s_and_b32 s36, s3, 1
  s_mul_i32 s36, s36, 16896
  s_add_u32 s36, s36, 78144
  v_add_u32 v21, s36, v20
  s_mul_i32 s36, s63, 16896
  s_add_u32 s36, s36, 55968
  v_add_u32 v20, s36, v20
  v_and_b32 v26, 7, v1
  v_mul_u32_u24 v26, 656, v26
  v_add_u32 v26, 115342, v26
  v_mov_b32 v32, 0
  s_lshl_b32 s36, s39, 16
  s_cmp_eq_u32 s29, 0
  s_cselect_b32 s36, s36, 0
  v_mov_b32 v27, 0
  v_writelane_b32 v27, s36, 0
  s_lshl_b32 s40, s22, 1
  s_and_b32 s41, s23, 1
  s_add_u32 s40, s40, s41
  s_lshr_b32 s41, s23, 1
  s_mov_b32 s99, s41
  s_mul_i32 s42, s40, 7
  s_lshr_b32 s42, s42, 1
  s_lshr_b32 s43, s42, 3
  s_add_u32 s44, s42, 3
  s_lshr_b32 s44, s44, 3
  s_lshl_b32 s43, s43, 9
  s_lshl_b32 s44, s44, 9
  v_mov_b32 v252, s43
  v_mov_b32 v253, s44
  v_cmp_lt_u32 vcc, 31, v1
  s_nop 1
  v_cndmask_b32 v252, v252, v253, vcc
  v_and_b32 v253, 31, v1
  v_lshl_add_u32 v252, v253, 4, v252
  v_add_u32 v252, 32768, v252
  s_waitcnt lgkmcnt(0)
  s_barrier
  ds_read_b32 v255, v250 offset:8
  ds_read_b128 v[112:115], v20 offset:0
  s_lshl_b32 s40, s22, 1
  s_and_b32 s41, s23, 1
  s_add_u32 s40, s40, s41
  s_lshr_b32 s41, s23, 1
  ds_read_b128 v[144:147], v21 offset:0
  s_mov_b32 s99, s41
  s_mul_i32 s42, s40, 7
  s_lshr_b32 s42, s42, 1
  s_and_b32 s24, s3, 1
  ds_read_b128 v[116:119], v20 offset:64
  s_lshr_b32 s27, s3, 1
  s_cmp_lt_u32 s23, 28
  s_cselect_b32 s34, 16, 16
  s_sub_u32 s35, 32, s34
  ds_read_b128 v[148:151], v21 offset:64
  s_min_u32 s54, s27, 2
  s_mul_i32 s54, s54, s34
  s_cmp_eq_u32 s27, 3
  s_cselect_b32 s55, s35, 0
  ds_read_b128 v[120:123], v20 offset:128
  s_add_u32 s54, s54, s55
  s_cmp_lt_u32 s3, 4
  s_cselect_b32 s34, s34, s35
  s_lshr_b32 s35, s34, 2
  ds_read_b128 v[152:155], v21 offset:128
  s_lshl_b32 s96, s42, 9
  s_lshl_b32 s28, s41, 2
  s_lshl_b32 s31, s24, 1
  s_add_u32 s28, s28, s31
  ds_read_b128 v[124:127], v20 offset:192
  s_mul_i32 s31, s28, 28672
  s_add_u32 s31, s31, 131072
  s_add_u32 s30, s31, 28672
  s_mul_i32 s54, s54, 28672
  ds_read_b128 v[156:159], v21 offset:192
  s_add_u32 s54, s54, 1966080
  s_mul_i32 s55, s34, 28672
  s_add_u32 s55, s55, s54
  s_mul_i32 s33, s99, s34
  ds_read_b128 v[128:131], v20 offset:256
  s_lshr_b32 s33, s33, 4
  s_mul_i32 s33, s33, 28672
  s_add_u32 s33, s33, s54
  s_mul_i32 s97, s40, 448
  ds_read_b128 v[160:163], v21 offset:256
  s_add_u32 s97, s97, 1835008
  s_mov_b32 s46, 0x0fffffff
  s_mov_b32 s47, 0x0fffffff
  s_mov_b32 s8, s68
  ds_read_b128 v[132:135], v20 offset:320
  s_and_b32 s9, s69, 0xffff
  s_mov_b32 s10, 401408
  s_mov_b32 s11, 0x20000
  s_lshr_b32 s52, s40, 2
  ds_read_b128 v[164:167], v21 offset:320
  s_lshl_b32 s53, s41, 2
  s_add_u32 s52, s52, s53
  s_and_b32 s53, s40, 3
  s_lshl_b32 s98, s53, 8
  s_waitcnt lgkmcnt(10)
  v_mfma_f32_16x16x32_bf16 v[176:179], v[112:115], v[144:147], 0
  ds_read_b128 v[136:139], v20 offset:384
  s_lshl_b32 s51, s3, 10
  s_mul_i32 s50, s3, 3584
  s_sub_u32 s35, s35, 1
  s_and_b32 s49, s40, 1
  ds_read_b128 v[168:171], v21 offset:384
  v_readfirstlane_b32 s20, v255
  s_waitcnt vmcnt(0)
  v_mov_b32 v2, s60
  v_mov_b32 v3, s20
  s_mov_b64 exec, 1
  buffer_store_dword v3, v2, s[16:19], 0 offen sc1
  s_mov_b64 exec, -1
  s_cmp_eq_u32 s49, 0
  s_cselect_b32 s43, -1, 0
  s_mov_b32 s42, 0
  s_cselect_b32 s44, 0, -1
  s_waitcnt lgkmcnt(10)
  v_mfma_f32_16x16x32_bf16 v[176:179], v[116:119], v[148:151], v[176:179]
  ds_read_b128 v[140:143], v20 offset:448
  s_mov_b32 s45, 0
  s_lshl_b32 s32, s21, 4
  s_and_b32 s49, s3, 3
  s_lshl_b32 s49, s49, 2
  ds_read_b128 v[172:175], v21 offset:448
  s_add_u32 s32, s32, s49
  s_add_u32 s32, s32, 102400
  s_cmp_lt_u32 s23, 28
  s_cselect_b32 s32, s32, 11403264
  s_waitcnt lgkmcnt(10)
  v_mfma_f32_16x16x32_bf16 v[176:179], v[120:123], v[152:155], v[176:179]
  ds_read_b128 v[112:115], v20 offset:512
  s_lshl_b32 s36, s24, 14
  s_add_u32 s36, s36, 98304
  s_lshr_b32 s5, s27, 1
  s_lshl_b32 s5, s5, 15
  ds_read_b128 v[144:147], v21 offset:512
  s_and_b32 s49, s27, 1
  s_lshl_b32 s49, s49, 11
  s_add_u32 s5, s5, s49
  s_add_u32 s5, s5, s36
  s_waitcnt lgkmcnt(10)
  v_mfma_f32_16x16x32_bf16 v[176:179], v[124:127], v[156:159], v[176:179]
  ds_read_b128 v[116:119], v20 offset:576
  s_lshl_b32 s6, s27, 12
  s_add_u32 s6, s6, s36
  s_or_b32 s7, s27, 1
  s_lshl_b32 s7, s7, 12
  ds_read_b128 v[148:151], v21 offset:576
  s_add_u32 s7, s7, s36
  s_add_u32 s7, s7, 1536
  s_and_b32 s36, s27, 1
  s_cmp_eq_u32 s36, 1
  s_waitcnt lgkmcnt(10)
  v_mfma_f32_16x16x32_bf16 v[176:179], v[128:131], v[160:163], v[176:179]
  ds_read_b128 v[120:123], v20 offset:640
  s_cselect_b32 s101, -1, 0
  s_mov_b32 s100, 0
  s_lshr_b32 s4, s27, 1
  s_add_u32 s4, s4, s28
  ds_read_b128 v[152:155], v21 offset:640
  s_lshl_b32 s4, s4, 15
  s_lshl_b32 s49, s40, 11
  s_add_u32 s4, s4, s49
  s_lshl_b32 s49, s36, 10
  s_waitcnt lgkmcnt(10)
  v_mfma_f32_16x16x32_bf16 v[176:179], v[132:135], v[164:167], v[176:179]
  ds_read_b128 v[124:127], v20 offset:704
  s_add_u32 s4, s4, s49
  s_add_u32 s4, s4, 5636096
  s_lshl_b32 s92, s25, 9
  s_add_u32 s92, s92, 102400
  ds_read_b128 v[156:159], v21 offset:704
  s_lshl_b32 s93, s25, 18
  s_lshl_b32 s36, s26, 7
  s_add_u32 s93, s93, s36
  s_and_b32 s36, s3, 3
  s_waitcnt lgkmcnt(10)
  v_mfma_f32_16x16x32_bf16 v[176:179], v[136:139], v[168:171], v[176:179]
  ds_read_b128 v[128:131], v20 offset:768
  s_lshl_b32 s36, s36, 5
  s_add_u32 s93, s93, s36
  s_add_u32 s93, s93, 9568256
  ds_read_b128 v[160:163], v21 offset:768
  s_waitcnt lgkmcnt(10)
  v_mfma_f32_16x16x32_bf16 v[176:179], v[140:143], v[172:175], v[176:179]
  ds_read_b128 v[132:135], v20 offset:832
  ds_read_b128 v[164:167], v21 offset:832
  s_waitcnt lgkmcnt(10)
  v_mfma_f32_16x16x32_bf16 v[176:179], v[112:115], v[144:147], v[176:179]
  ds_read_b128 v[136:139], v20 offset:896
  ds_read_b128 v[168:171], v21 offset:896
  s_waitcnt lgkmcnt(10)
  v_mfma_f32_16x16x32_bf16 v[176:179], v[116:119], v[148:151], v[176:179]
  ds_read_b128 v[140:143], v20 offset:960
  ds_read_b128 v[172:175], v21 offset:960
  s_waitcnt lgkmcnt(10)
  v_mfma_f32_16x16x32_bf16 v[176:179], v[120:123], v[152:155], v[176:179]
  s_waitcnt lgkmcnt(8)
  v_mfma_f32_16x16x32_bf16 v[176:179], v[124:127], v[156:159], v[176:179]
  s_waitcnt lgkmcnt(6)
  v_mfma_f32_16x16x32_bf16 v[176:179], v[128:131], v[160:163], v[176:179]
  s_waitcnt lgkmcnt(4)
  v_mfma_f32_16x16x32_bf16 v[176:179], v[132:135], v[164:167], v[176:179]
  s_waitcnt lgkmcnt(2)
  v_mfma_f32_16x16x32_bf16 v[176:179], v[136:139], v[168:171], v[176:179]
  s_waitcnt lgkmcnt(0)
  v_mfma_f32_16x16x32_bf16 v[176:179], v[140:143], v[172:175], v[176:179]
  ds_write_b16 v26, v32
  s_nop 6
  v_add_f32 v176, v176, v27
  v_cvt_pk_bf16_f32 v180, v176, v177
  v_cvt_pk_bf16_f32 v181, v178, v179
  ds_write_b16 v22, v180
  ds_write_b16_d16_hi v23, v180
  ds_write_b16 v24, v181
  ds_write_b16_d16_hi v25, v181
  s_waitcnt lgkmcnt(0)
  s_barrier
  ds_read_u16 v64, v224 offset:0
  ds_read_u16 v65, v225 offset:0
  ds_read_u16 v66, v226 offset:0
  ds_read_u16 v67, v227 offset:0
  ds_read_u16 v68, v228 offset:0
  ds_read_u16 v69, v229 offset:0
  ds_read_u16 v70, v230 offset:0
  ds_read_u16 v71, v231 offset:0
  ds_read_u16 v72, v232 offset:0
  ds_read_u16 v73, v233 offset:0
  ds_read_u16 v74, v234 offset:0
  s_waitcnt lgkmcnt(0)
  v_lshl_or_b32 v80, v65, 16, v64
  v_lshl_or_b32 v81, v67, 16, v66
  v_lshl_or_b32 v82, v69, 16, v68
  v_lshl_or_b32 v83, v71, 16, v70
  ds_write_b128 v249, v[80:83] offset:0
  v_lshl_or_b32 v84, v66, 16, v65
  v_lshl_or_b32 v85, v68, 16, v67
  v_lshl_or_b32 v86, v70, 16, v69
  v_lshl_or_b32 v87, v72, 16, v71
  ds_write_b128 v249, v[84:87] offset:8384
  v_lshl_or_b32 v88, v67, 16, v66
  v_lshl_or_b32 v89, v69, 16, v68
  v_lshl_or_b32 v90, v71, 16, v70
  v_lshl_or_b32 v91, v73, 16, v72
  ds_write_b128 v249, v[88:91] offset:16768
  v_lshl_or_b32 v92, v68, 16, v67
  v_lshl_or_b32 v93, v70, 16, v69
  v_lshl_or_b32 v94, v72, 16, v71
  v_lshl_or_b32 v95, v74, 16, v73
  ds_write_b128 v249, v[92:95] offset:25152
  v_mov_b32 v249, 97280
  s_waitcnt lgkmcnt(0)
  s_barrier
  s_setprio 2
  s_cmp_lg_u32 s3, 0
  s_cbranch_scc1 Q_nq
  buffer_load_dwordx4 v[244:247], v252, s[16:19], 0 offen sc1
Q_nq:
  v_lshl_add_u32 v3, v1, 4, s96
  v_and_b32 v5, 31, v1
  v_lshrrev_b32 v6, 5, v1
  v_mul_u32_u24 v4, 7168, v6
  v_lshl_add_u32 v4, v5, 4, v4
  v_add_u32 v4, s97, v4
  v_add_u32 v7, 14336, v4
  v_cmp_eq_u32 vcc, 28, v5
  v_mov_b32 v12, 0x3f803f80
  s_nop 0
  v_cndmask_b32 v12, 0, v12, vcc
  v_mov_b32 v13, v12
  v_mov_b64 v[144:145], v[12:13]
  v_mov_b64 v[146:147], v[12:13]
  v_mov_b64 v[148:149], v[12:13]
  v_mov_b64 v[150:151], v[12:13]
  v_mov_b64 v[152:153], v[12:13]
  v_mov_b64 v[154:155], v[12:13]
  v_mov_b64 v[156:157], v[12:13]
  v_mov_b64 v[158:159], v[12:13]
  v_mov_b64 v[160:161], v[12:13]
  v_mov_b64 v[162:163], v[12:13]
  v_mov_b64 v[164:165], v[12:13]
  v_mov_b64 v[166:167], v[12:13]
  v_mov_b64 v[168:169], v[12:13]
  v_mov_b64 v[170:171], v[12:13]
  v_mov_b64 v[172:173], v[12:13]
  v_mov_b64 v[174:175], v[12:13]
  v_lshrrev_b32 v8, 4, v1
  v_and_b32 v9, 15, v1
  v_lshlrev_b32 v10, 2, v8
  v_xor_b32 v9, v9, v10
  v_lshlrev_b32 v9, 4, v9
  v_mul_u32_u24 v8, 896, v8
  v_add_u32 v8, v8, v9
  v_add_u32 v8, s98, v8
  v_lshl_add_u32 v240, v1, 4, s5
  v_lshl_add_u32 v241, v1, 4, s6
  v_lshl_add_u32 v242, v5, 4, s7
  v_lshlrev_b32 v243, 13, v6
  v_lshl_add_u32 v243, v5, 4, v243
  v_add_u32 v243, 103936, v243
  v_lshl_add_u32 v238, v5, 4, s92
  v_lshlrev_b32 v239, 12, v1
  v_mov_b64 v[32:33], 0
  v_mov_b64 v[34:35], 0
  v_mov_b64 v[36:37], 0
  v_mov_b64 v[38:39], 0
  v_mov_b64 v[40:41], 0
  v_mov_b64 v[42:43], 0
  v_mov_b64 v[44:45], 0
  v_mov_b64 v[46:47], 0
  v_mov_b64 v[48:49], 0
  v_mov_b64 v[50:51], 0
  v_mov_b64 v[52:53], 0
  v_mov_b64 v[54:55], 0
  v_mov_b64 v[56:57], 0
  v_mov_b64 v[58:59], 0
  v_mov_b64 v[60:61], 0
  v_mov_b64 v[62:63], 0
  v_mov_b64 v[104:105], 0
  v_mov_b64 v[106:107], 0
  v_mov_b64 v[108:109], 0
  v_mov_b64 v[110:111], 0
  v_mov_b64 v[92:93], 0
  v_mov_b64 v[94:95], 0
  s_cmp_lg_u32 s3, 0
  s_cbranch_scc1 Q_w1
  s_waitcnt vmcnt(0)
  v_xor_b32 v244, s20, v244
  v_xor_b32 v245, s20, v245
  v_xor_b32 v246, s20, v246
  v_xor_b32 v247, s20, v247
  v_or3_b32 v244, v244, v245, v246
  v_or_b32 v244, v244, v247
  v_cmp_ne_u32 vcc, 0, v244
  s_nop 4
  s_cbranch_vccz Q_w0
  s_mov_b32 s62, 0
PL_f1:
  buffer_load_dwordx4 v[244:247], v252, s[16:19], 0 offen sc1
  s_waitcnt vmcnt(0)
  v_xor_b32 v244, s20, v244
  v_xor_b32 v245, s20, v245
  v_xor_b32 v246, s20, v246
  v_xor_b32 v247, s20, v247
  v_or3_b32 v244, v244, v245, v246
  v_or_b32 v244, v244, v247
  v_cmp_ne_u32 vcc, 0, v244
  s_nop 4
  s_cbranch_vccz PL_f1_ok
  s_sleep 1
  s_add_u32 s62, s62, 1
  s_cmp_lt_u32 s62, 1000000
  s_cbranch_scc1 PL_f1
PL_f1_ok:
  s_mov_b64 exec, -1
Q_w0:
  ds_write_b32 v250, v251 offset:12
  s_branch L_pre
Q_w1:
GW1:
  ds_read_b32 v2, v250 offset:12
  s_waitcnt lgkmcnt(0)
  v_readfirstlane_b32 s62, v2
  s_nop 0
  s_cmp_ge_u32 s62, 1
  s_cbranch_scc1 GW1_ok
  s_sleep 1
  s_add_u32 s95, s95, 1
  s_cmp_lt_u32 s95, 0x2000000
  s_cbranch_scc1 GW1
GW1_ok:
L_pre:
  buffer_load_dwordx4 v[16:19], v3, s[16:19], s31 offen
  buffer_load_dwordx4 v[20:23], v3, s[16:19], s31 offen offset:1024
  buffer_load_dwordx4 v[112:115], v3, s[16:19], s33 offen
  buffer_load_dwordx4 v[116:119], v3, s[16:19], s33 offen offset:1024
  buffer_load_dwordx4 v[24:27], v3, s[16:19], s30 offen
  buffer_load_dwordx4 v[28:31], v3, s[16:19], s30 offen offset:1024
  s_mov_b64 exec, s[46:47]
  buffer_load_dwordx4 v[144:147], v4, s[16:19], s33 offen
  buffer_load_dwordx4 v[148:151], v7, s[16:19], s33 offen
  s_mov_b64 exec, -1
  s_add_u32 s33, s33, 28672
  s_cmp_eq_u32 s33, s55
  s_cselect_b32 s33, s54, s33
  buffer_load_dwordx4 v[120:123], v3, s[16:19], s33 offen
  buffer_load_dwordx4 v[124:127], v3, s[16:19], s33 offen offset:1024
  s_waitcnt vmcnt(4)
  s_mov_b64 exec, s[42:43]
  v_mov_b32 v22, 0
  v_mov_b32 v23, 0
  v_mov_b32 v30, 0
  v_mov_b32 v31, 0
  s_mov_b64 exec, s[44:45]
  v_mov_b32 v16, 0
  v_mov_b32 v17, 0
  v_mov_b32 v24, 0
  v_mov_b32 v25, 0
  s_mov_b64 exec, -1
  v_mfma_f32_32x32x16_bf16 v[64:79], v[112:115], v[16:19], 0
  v_mfma_f32_32x32x16_bf16 v[64:79], v[116:119], v[20:23], v[64:79]
  s_mov_b64 exec, s[46:47]
  buffer_load_dwordx4 v[152:155], v4, s[16:19], s33 offen
  buffer_load_dwordx4 v[156:159], v7, s[16:19], s33 offen
  s_mov_b64 exec, -1
  s_add_u32 s33, s33, 28672
  s_cmp_eq_u32 s33, s55
  s_cselect_b32 s33, s54, s33
  buffer_load_dwordx4 v[128:131], v3, s[16:19], s33 offen
  buffer_load_dwordx4 v[132:135], v3, s[16:19], s33 offen offset:1024
  s_mov_b64 exec, s[46:47]
  buffer_load_dwordx4 v[160:163], v4, s[16:19], s33 offen
  buffer_load_dwordx4 v[164:167], v7, s[16:19], s33 offen
  s_mov_b64 exec, -1
  s_add_u32 s33, s33, 28672
  s_cmp_eq_u32 s33, s55
  s_cselect_b32 s33, s54, s33
  buffer_load_dwordx4 v[136:139], v3, s[16:19], s33 offen
  buffer_load_dwordx4 v[140:143], v3, s[16:19], s33 offen offset:1024
  s_setprio 0
  s_branch L_att2
Q_ssm:
  s_setprio 0
  v_and_b32 v14, 255, v0
  s_lshl_b32 s37, s21, 10
  v_lshl_add_u32 v248, v14, 1, s37
  s_lshl_b32 s28, s29, 1
  v_xor_b32 v5, s28, v4
  v_lshlrev_b32 v5, 4, v5
  s_lshl_b32 s30, s26, 6
  s_lshl_b32 s31, s29, 4
  s_add_u32 s30, s30, s31
  v_add_u32 v6, s30, v3
  v_mul_u32_u24 v6, 896, v6
  s_lshl_b32 s31, s25, 7
  v_add_u32 v6, s31, v6
  v_add_u32 v7, v6, v5
  v_xor_b32 v5, 16, v5
  v_add_u32 v6, v6, v5
  v_add_u32 v6, 7168, v6
  s_lshl_b32 s31, s61, 11
  s_mul_i32 s32, s63, 7680
  s_add_u32 s31, s31, s32
  s_add_u32 s31, s31, 133632
  s_mov_b32 m0, s31
  s_lshl_b32 s36, s21, 2
  s_waitcnt lgkmcnt(0)
  s_mov_b32 s16, s88
  s_and_b32 s17, s89, 0xffff
  s_mov_b32 s18, 11403264
  s_mov_b32 s19, 0x20000
  s_mov_b32 s33, 98304
  buffer_load_dword v253, off, s[16:19], s33 sc1
  s_mov_b32 s40, s72
  s_and_b32 s41, s73, 0xffff
  s_mov_b32 s42, 229376
  s_mov_b32 s43, 0x20000
  buffer_load_ushort v240, v248, s[40:43], 0 offen nt
  buffer_load_ushort v244, v248, s[40:43], 0 offen offset:512 nt
  s_mov_b32 s44, s74
  s_and_b32 s45, s75, 0xffff
  s_mov_b32 s46, 229376
  s_mov_b32 s47, 0x20000
  buffer_load_ushort v241, v248, s[44:47], 0 offen nt
  buffer_load_ushort v245, v248, s[44:47], 0 offen offset:512 nt
  s_mov_b32 s48, s76
  s_and_b32 s49, s77, 0xffff
  s_mov_b32 s50, 229376
  s_mov_b32 s51, 0x20000
  buffer_load_ushort v242, v248, s[48:51], 0 offen nt
  buffer_load_ushort v246, v248, s[48:51], 0 offen offset:512 nt
  s_mov_b32 s52, s78
  s_and_b32 s53, s79, 0xffff
  s_mov_b32 s54, 229376
  s_mov_b32 s55, 0x20000
  buffer_load_ushort v243, v248, s[52:55], 0 offen nt
  buffer_load_ushort v247, v248, s[52:55], 0 offen offset:512 nt
  s_mov_b32 s8, s70
  s_and_b32 s9, s71, 0xffff
  s_mov_b32 s10, 1835008
  s_mov_b32 s11, 0x20000
  v_mov_b32 v54, v7
  v_mov_b32 v55, v6
  s_mov_b32 s34, s31
  buffer_load_dwordx4 v54, s[8:11], 0 offen nt lds
  s_add_u32 m0, s34, 1024
  s_nop 0
  buffer_load_dwordx4 v55, s[8:11], 0 offen nt lds
  s_add_u32 s80, s80, s36
  s_addc_u32 s81, s81, 0
  s_add_u32 s82, s82, s36
  s_addc_u32 s83, s83, 0
  s_load_dword s38, s[80:81], 0
  s_load_dword s39, s[82:83], 0
  s_mov_b32 s12, s84
  s_and_b32 s13, s85, 0xffff
  s_mov_b32 s14, 3670016
  s_mov_b32 s15, 0x20000
  v_and_b32 v5, 1, v1
  v_bfe_u32 v6, v1, 1, 1
  v_lshrrev_b32 v7, 4, v1
  v_add_u32 v2, s28, v5
  v_xor_b32 v7, v7, v2
  v_lshlrev_b32 v7, 4, v7
  v_lshl_add_u32 v7, v6, 3, v7
  v_bfe_u32 v6, v1, 2, 2
  v_lshl_add_u32 v6, v5, 3, v6
  v_lshl_add_u32 v7, v6, 7, v7
  v_add_u32 v50, s31, v7
  v_xor_b32 v51, 64, v50
  s_lshl_b32 s31, s25, 18
  s_lshl_b32 s33, s26, 9
  s_add_u32 s31, s31, s33
  s_lshl_b32 s33, s29, 7
  s_add_u32 s31, s31, s33
  s_add_u32 s31, s31, 7733248
  v_lshlrev_b32 v52, 14, v3
  v_lshl_add_u32 v52, v4, 4, v52
  v_add_u32 v52, s31, v52
  s_lshl_b32 s59, s25, 9
  s_lshl_b32 s33, s26, 4
  s_add_u32 s59, s59, s33
  s_lshl_b32 s33, s29, 2
  s_add_u32 s59, s59, s33
  v_and_b32 v20, 15, v1
  v_lshrrev_b32 v21, 4, v1
  v_mul_u32_u24 v20, 1056, v20
  v_lshl_add_u32 v20, v21, 4, v20
  s_and_b32 s36, s3, 1
  s_mul_i32 s36, s36, 16896
  s_add_u32 s36, s36, 22176
  v_add_u32 v21, s36, v20
  s_mul_i32 s36, s63, 16896
  s_add_u32 s36, s36, 0
  v_add_u32 v20, s36, v20
  v_and_b32 v26, 7, v1
  v_mul_u32_u24 v26, 656, v26
  v_add_u32 v26, 120590, v26
  v_mov_b32 v32, 0
  s_mov_b32 s101, 4096
  v_and_b32 v2, 3, v1
  v_mul_u32_u24 v2, 8384, v2
  v_bfe_u32 v3, v1, 2, 2
  v_lshl_add_u32 v2, v3, 4, v2
  v_bfe_u32 v3, v1, 4, 1
  v_mul_u32_u24 v3, 4160, v3
  v_add3_u32 v217, v2, v3, s101
  s_lshl_b32 s36, s21, 1
  s_lshr_b32 s56, s36, 2
  s_lshl_b32 s56, s56, 14
  s_and_b32 s36, s36, 3
  s_lshl_b32 s36, s36, 4
  s_add_u32 s56, s56, s36
  s_add_u32 s56, s56, 7733248
  s_mov_b32 s57, s56
  v_add_u32 v2, 0, v1
  v_mul_u32_u24 v3, 205, v2
  v_lshrrev_b32 v3, 10, v3
  v_mul_u32_u24 v4, 5, v3
  v_sub_u32 v4, v2, v4
  v_min_u32 v4, 3, v4
  v_lshl_add_u32 v3, v3, 2, v4
  v_lshlrev_b32 v220, 6, v3
  v_add_u32 v2, 64, v1
  v_mul_u32_u24 v3, 205, v2
  v_lshrrev_b32 v3, 10, v3
  v_mul_u32_u24 v4, 5, v3
  v_sub_u32 v4, v2, v4
  v_min_u32 v4, 3, v4
  v_lshl_add_u32 v3, v3, 2, v4
  v_lshlrev_b32 v221, 6, v3
  v_add_u32 v2, 128, v1
  v_mul_u32_u24 v3, 205, v2
  v_lshrrev_b32 v3, 10, v3
  v_mul_u32_u24 v4, 5, v3
  v_sub_u32 v4, v2, v4
  v_min_u32 v4, 3, v4
  v_lshl_add_u32 v3, v3, 2, v4
  v_lshlrev_b32 v222, 6, v3
  v_add_u32 v2, 192, v1
  v_mul_u32_u24 v3, 205, v2
  v_lshrrev_b32 v3, 10, v3
  v_mul_u32_u24 v4, 5, v3
  v_sub_u32 v4, v2, v4
  v_min_u32 v4, 3, v4
  v_lshl_add_u32 v3, v3, 2, v4
  v_lshlrev_b32 v252, 6, v3
  v_add_u32 v2, 256, v1
  v_mul_u32_u24 v3, 205, v2
  v_lshrrev_b32 v3, 10, v3
  v_mul_u32_u24 v4, 5, v3
  v_sub_u32 v4, v2, v4
  v_min_u32 v4, 3, v4
  v_lshl_add_u32 v3, v3, 2, v4
  v_lshlrev_b32 v255, 6, v3
  s_lshr_b32 s36, s21, 5
  s_lshl_b32 s36, s36, 9
  v_and_b32 v17, 31, v1
  v_lshl_add_u32 v223, v17, 4, s36
  v_lshrrev_b32 v18, 5, v1
  v_and_b32 v19, 3, v17
  v_sub_u32 v19, 3, v19
  v_mul_u32_u24 v19, 8384, v19
  v_lshrrev_b32 v2, 2, v17
  v_lshlrev_b32 v3, 1, v18
  v_sub_u32 v2, v3, v2
  v_lshl_add_u32 v19, v2, 3, v19
  s_mul_i32 s36, s61, 4160
  s_lshl_b32 s56, s63, 10
  s_sub_u32 s36, s36, s56
  s_add_u32 s36, s36, 1080
  v_add_u32 v218, s36, v19
  v_mul_u32_u24 v2, 80, v17
  v_lshl_add_u32 v2, v18, 4, v2
  s_mul_i32 s36, s61, 7680
  s_mul_i32 s56, s63, 1280
  s_sub_u32 s36, s36, s56
  s_add_u32 s36, s36, 132432
  v_add_u32 v219, s36, v2
  v_mov_b64 v[32:33], 0
  v_mov_b64 v[34:35], 0
  v_and_b32 v14, 255, v0
  v_lshlrev_b32 v36, 4, v14
  v_add_u32 v36, 131072, v36
  v_cmp_gt_u32 vcc, 160, v14
  s_nop 0
  s_mov_b64 exec, vcc
  ds_write_b128 v36, v[32:35]
  ds_write_b128 v36, v[32:35] offset:7680
  s_mov_b64 exec, -1
  ds_write2_b32 v250, v32, v33 offset0:1 offset1:3
  ds_write_b32 v250, v32
  s_waitcnt lgkmcnt(0)
  s_barrier
  s_setprio 0
  v_and_b32 v14, 255, v0
  v_lshlrev_b32 v249, 4, v14
  v_add_u32 v15, 147456, v249
  ds_read_b128 v[224:227], v15 offset:0
  ds_read_b128 v[228:231], v15 offset:4096
  ds_read_b128 v[232:235], v15 offset:8192
  ds_read_b128 v[22:25], v15 offset:12288
  s_and_b32 s36, s39, 0xffff0000
  s_cmp_eq_u32 s29, 0
  s_cselect_b32 s36, s36, 0
  v_mov_b32 v27, 0
  v_writelane_b32 v27, s36, 0
  s_lshl_b32 s40, s22, 1
  s_and_b32 s41, s23, 1
  s_add_u32 s40, s40, s41
  s_lshr_b32 s41, s23, 1
  s_mov_b32 s99, s41
  s_mul_i32 s42, s40, 7
  s_lshr_b32 s42, s42, 1
  s_and_b32 s24, s3, 1
  s_lshr_b32 s27, s3, 1
  s_cmp_lt_u32 s23, 28
  s_cselect_b32 s34, 16, 16
  s_sub_u32 s35, 32, s34
  s_min_u32 s54, s27, 2
  s_mul_i32 s54, s54, s34
  s_cmp_eq_u32 s27, 3
  s_cselect_b32 s55, s35, 0
  s_add_u32 s54, s54, s55
  s_cmp_lt_u32 s3, 4
  s_cselect_b32 s34, s34, s35
  s_lshr_b32 s35, s34, 2
  s_lshl_b32 s96, s42, 9
  s_lshl_b32 s28, s41, 2
  s_lshl_b32 s31, s24, 1
  s_add_u32 s28, s28, s31
  s_mul_i32 s31, s28, 28672
  s_add_u32 s31, s31, 131072
  s_add_u32 s30, s31, 28672
  s_mul_i32 s54, s54, 28672
  s_add_u32 s54, s54, 1966080
  s_mul_i32 s55, s34, 28672
  s_add_u32 s55, s55, s54
  s_mul_i32 s33, s99, s34
  s_lshr_b32 s33, s33, 4
  s_mul_i32 s33, s33, 28672
  s_add_u32 s33, s33, s54
  s_mul_i32 s97, s40, 448
  s_add_u32 s97, s97, 1835008
  s_mov_b32 s46, 0x0fffffff
  s_mov_b32 s47, 0x0fffffff
  s_mov_b32 s8, s68
  s_and_b32 s9, s69, 0xffff
  s_mov_b32 s10, 401408
  s_mov_b32 s11, 0x20000
  s_lshr_b32 s52, s40, 2
  s_lshl_b32 s53, s41, 2
  s_add_u32 s52, s52, s53
  s_and_b32 s53, s40, 3
  s_lshl_b32 s98, s53, 8
  s_lshl_b32 s51, s3, 10
  s_mul_i32 s50, s3, 3584
  s_sub_u32 s35, s35, 1
  s_and_b32 s49, s40, 1
  s_cmp_eq_u32 s49, 0
  s_cselect_b32 s43, -1, 0
  s_mov_b32 s42, 0
  s_cselect_b32 s44, 0, -1
  s_mov_b32 s45, 0
  s_lshl_b32 s32, s21, 4
  s_and_b32 s49, s3, 3
  s_lshl_b32 s49, s49, 2
  s_add_u32 s32, s32, s49
  s_add_u32 s32, s32, 102400
  s_cmp_lt_u32 s23, 28
  s_cselect_b32 s32, s32, 11403264
  s_lshl_b32 s36, s24, 14
  s_add_u32 s36, s36, 98304
  s_lshr_b32 s5, s27, 1
  s_lshl_b32 s5, s5, 15
  s_and_b32 s49, s27, 1
  s_lshl_b32 s49, s49, 11
  s_add_u32 s5, s5, s49
  s_add_u32 s5, s5, s36
  s_lshl_b32 s6, s27, 12
  s_add_u32 s6, s6, s36
  s_or_b32 s7, s27, 1
  s_lshl_b32 s7, s7, 12
  s_add_u32 s7, s7, s36
  s_add_u32 s7, s7, 1536
  s_and_b32 s36, s27, 1
  s_cmp_eq_u32 s36, 1
  s_cselect_b32 s101, -1, 0
  s_mov_b32 s100, 0
  s_lshr_b32 s4, s27, 1
  s_add_u32 s4, s4, s28
  s_lshl_b32 s4, s4, 15
  s_lshl_b32 s49, s40, 11
  s_add_u32 s4, s4, s49
  s_lshl_b32 s49, s36, 10
  s_add_u32 s4, s4, s49
  s_add_u32 s4, s4, 5636096
  s_lshl_b32 s92, s25, 9
  s_add_u32 s92, s92, 102400
  s_lshl_b32 s93, s25, 18
  s_lshl_b32 s36, s26, 7
  s_add_u32 s93, s93, s36
  s_and_b32 s36, s3, 3
  s_lshl_b32 s36, s36, 5
  s_add_u32 s93, s93, s36
  s_add_u32 s93, s93, 9568256
  s_barrier
  s_waitcnt vmcnt(2)
  v_add_u32 v253, 1, v253
  s_and_b32 s58, s38, 0xffff0000
  v_mov_b32 v204, s58
  v_mul_f32 v204, 1069066811, v204
  v_exp_f32 v204, v204
  v_lshlrev_b32 v202, 16, v244
  v_lshlrev_b32 v203, 16, v245
  v_lshlrev_b32 v170, 16, v246
  v_lshlrev_b32 v171, 16, v247
  v_cvt_pk_bf16_f32 v204, v204, v204
  v_mul_f32 v202, 1069066811, v202
  v_exp_f32 v202, v202
  v_and_b32 v204, 0xffff0000, v204
  v_mul_f32 v203, v203, v204
  v_cvt_pk_bf16_f32 v202, v202, v202
  v_and_b32 v202, 0xffff0000, v202
  v_mul_f32 v202, v202, v204
  v_mul_f32 v202, 3216550459, v202
  v_mul_f32 v203, 1042479491, v203
  v_add_f32 v204, v204, v204
  v_mul_f32 v170, v170, v204
  v_mul_f32 v171, v171, v204
  v_mul_f32 v206, 1065353216, v202
  v_mul_f32 v207, 1065353216, v203
  v_exp_f32 v206, v206
  v_fract_f32 v207, v207
  v_cos_f32 v208, v207
  v_sin_f32 v209, v207
  v_mul_f32 v172, v206, v208
  v_mul_f32 v173, v206, v209
  v_mul_f32 v206, 1090519040, v202
  v_mul_f32 v207, 1090519040, v203
  v_exp_f32 v206, v206
  v_fract_f32 v207, v207
  v_cos_f32 v208, v207
  v_sin_f32 v209, v207
  v_mul_f32 v174, v206, v208
  v_mul_f32 v175, v206, v209
  v_mul_f32 v206, 1132462080, v202
  v_mul_f32 v207, 1132462080, v203
  v_exp_f32 v206, v206
  v_fract_f32 v207, v207
  v_cos_f32 v208, v207
  v_sin_f32 v209, v207
  v_mul_f32 v176, v206, v208
  v_mul_f32 v177, v206, v209
  v_mul_f32 v206, v173, v173
  v_mul_f32 v207, v172, v173
  v_fma_f32 v178, v172, v172, -v206
  v_fma_f32 v179, v173, v172, v207
  v_mul_f32 v208, v175, v175
  v_mul_f32 v209, v174, v175
  v_fma_f32 v182, v174, v174, -v208
  v_fma_f32 v183, v175, v174, v209
  v_mul_f32 v206, v179, v179
  s_barrier
  v_mul_f32 v207, v178, v179
  v_fma_f32 v180, v178, v178, -v206
  v_fma_f32 v181, v179, v178, v207
  v_mul_f32 v208, v183, v183
  v_mul_f32 v209, v182, v183
  v_fma_f32 v184, v182, v182, -v208
  v_fma_f32 v185, v183, v182, v209
  v_mov_b32 v138, 0x3f80
  v_cvt_pk_bf16_f32 v139, v174, v175
  v_cvt_pk_bf16_f32 v140, v182, v183
  v_mul_f32 v192, v183, v175
  v_cvt_pk_bf16_f32 v117, v170, -v171
  v_mul_f32 v208, v171, v177
  v_cvt_pk_bf16_f32 v142, v184, v185
  v_mul_f32 v188, v175, v185
  v_mul_f32 v190, v183, v185
  v_mul_f32 v193, v182, v175
  v_mul_f32 v206, v171, v173
  v_mul_f32 v209, v170, v177
  v_mul_f32 v186, v185, v185
  v_mul_f32 v189, v174, v185
  v_mul_f32 v191, v182, v185
  v_fma_f32 v200, v182, v174, -v192
  v_mul_f32 v207, v170, v173
  v_fma_f32 v10, v170, v176, -v208
  v_mul_f32 v187, v184, v185
  v_fma_f32 v196, v174, v184, -v188
  v_fma_f32 v198, v182, v184, -v190
  v_fma_f32 v201, v183, v174, v193
  v_fma_f32 v40, v170, v172, -v206
  v_fma_f32 v11, v171, v176, v209
  v_fma_f32 v194, v184, v184, -v186
  v_fma_f32 v197, v175, v184, v189
  v_fma_f32 v199, v183, v184, v191
  v_cvt_pk_bf16_f32 v141, v200, v201
  v_fma_f32 v41, v171, v172, v207
  v_cvt_pk_bf16_f32 v125, v10, -v11
  v_fma_f32 v195, v185, v184, v187
  v_cvt_pk_bf16_f32 v143, v196, v197
  v_cvt_pk_bf16_f32 v144, v198, v199
  v_mul_f32 v192, v201, v185
  v_cvt_pk_bf16_f32 v118, v40, -v41
  v_mul_f32 v208, v11, v177
  v_cvt_pk_bf16_f32 v146, v194, v195
  v_mul_f32 v188, v197, v185
  v_mul_f32 v190, v199, v185
  v_mul_f32 v193, v200, v185
  v_mul_f32 v206, v41, v173
  v_mul_f32 v209, v10, v177
  v_mul_f32 v186, v195, v185
  v_mul_f32 v189, v196, v185
  v_mul_f32 v191, v198, v185
  v_fma_f32 v200, v200, v184, -v192
  v_mul_f32 v207, v40, v173
  v_fma_f32 v12, v10, v176, -v208
  v_mul_f32 v187, v194, v185
  v_fma_f32 v196, v196, v184, -v188
  v_fma_f32 v198, v198, v184, -v190
  v_fma_f32 v201, v201, v184, v193
  v_fma_f32 v40, v40, v172, -v206
  s_barrier
  v_fma_f32 v13, v11, v176, v209
  v_fma_f32 v194, v194, v184, -v186
  v_fma_f32 v197, v197, v184, v189
  v_fma_f32 v199, v199, v184, v191
  v_cvt_pk_bf16_f32 v145, v200, v201
  v_fma_f32 v41, v41, v172, v207
  v_cvt_pk_bf16_f32 v129, v12, -v13
  v_fma_f32 v195, v195, v184, v187
  v_cvt_pk_bf16_f32 v147, v196, v197
  v_cvt_pk_bf16_f32 v148, v198, v199
  v_mul_f32 v192, v201, v185
  v_cvt_pk_bf16_f32 v119, v40, -v41
  v_mul_f32 v208, v13, v177
  v_cvt_pk_bf16_f32 v150, v194, v195
  v_mul_f32 v188, v197, v185
  v_mul_f32 v190, v199, v185
  v_mul_f32 v193, v200, v185
  v_mul_f32 v206, v41, v173
  v_mul_f32 v209, v12, v177
  v_mul_f32 v186, v195, v185
  v_mul_f32 v189, v196, v185
  v_mul_f32 v191, v198, v185
  v_fma_f32 v200, v200, v184, -v192
  v_mul_f32 v207, v40, v173
  v_fma_f32 v18, v12, v176, -v208
  v_mul_f32 v187, v194, v185
  v_fma_f32 v196, v196, v184, -v188
  v_fma_f32 v198, v198, v184, -v190
  v_fma_f32 v201, v201, v184, v193
  v_fma_f32 v40, v40, v172, -v206
  v_fma_f32 v19, v13, v176, v209
  v_fma_f32 v194, v194, v184, -v186
  v_fma_f32 v197, v197, v184, v189
  v_fma_f32 v199, v199, v184, v191
  v_cvt_pk_bf16_f32 v149, v200, v201
  v_fma_f32 v41, v41, v172, v207
  v_cvt_pk_bf16_f32 v131, v18, -v19
  v_fma_f32 v195, v195, v184, v187
  v_cvt_pk_bf16_f32 v151, v196, v197
  v_cvt_pk_bf16_f32 v152, v198, v199
  v_mul_f32 v192, v201, v185
  v_cvt_pk_bf16_f32 v120, v40, -v41
  v_mul_f32 v208, v19, v177
  v_mul_f32 v48, v11, v179
  v_cvt_pk_bf16_f32 v154, v194, v195
  v_mul_f32 v188, v197, v185
  v_mul_f32 v190, v199, v185
  v_mul_f32 v193, v200, v185
  v_mul_f32 v206, v41, v173
  v_mul_f32 v209, v18, v177
  v_mul_f32 v49, v10, v179
  v_mul_f32 v186, v195, v185
  v_mul_f32 v189, v196, v185
  v_mul_f32 v191, v198, v185
  v_fma_f32 v200, v200, v184, -v192
  v_mul_f32 v207, v40, v173
  v_fma_f32 v42, v18, v176, -v208
  v_fma_f32 v44, v10, v178, -v48
  v_mul_f32 v187, v194, v185
  v_fma_f32 v196, v196, v184, -v188
  v_fma_f32 v198, v198, v184, -v190
  v_fma_f32 v201, v201, v184, v193
  v_fma_f32 v40, v40, v172, -v206
  v_fma_f32 v43, v19, v176, v209
  v_fma_f32 v45, v11, v178, v49
  s_barrier
  s_waitcnt vmcnt(0)
  ds_read_b64_tr_b16 v[54:55], v50
  ds_read_b64_tr_b16 v[56:57], v50 offset:512
  ds_read_b64_tr_b16 v[58:59], v51
  ds_read_b64_tr_b16 v[60:61], v51 offset:512
  s_mov_b32 s36, 131072
  s_lshl_b32 m0, s29, 8
  s_waitcnt lgkmcnt(0)
  buffer_store_dwordx4 v[54:57], v52, s[16:19], 0 offen sc1
  buffer_store_dwordx4 v[58:61], v52, s[16:19], s36 offen sc1
  v_readfirstlane_b32 s20, v253
  v_add_u32 v22, 5248, v22
  v_add_u32 v23, 5248, v23
  v_add_u32 v24, 5248, v24
  v_add_u32 v25, 5248, v25
  v_fma_f32 v194, v194, v184, -v186
  v_fma_f32 v197, v197, v184, v189
  v_fma_f32 v199, v199, v184, v191
  v_cvt_pk_bf16_f32 v153, v200, v201
  v_fma_f32 v41, v41, v172, v207
  v_cvt_pk_bf16_f32 v133, v42, -v43
  v_cvt_pk_bf16_f32 v126, v44, -v45
  v_fma_f32 v195, v195, v184, v187
  v_cvt_pk_bf16_f32 v155, v196, v197
  v_cvt_pk_bf16_f32 v156, v198, v199
  v_mul_f32 v192, v201, v185
  v_cvt_pk_bf16_f32 v121, v40, -v41
  v_mul_f32 v208, v43, v177
  v_mul_f32 v48, v11, v181
  v_cvt_pk_bf16_f32 v158, v194, v195
  v_mul_f32 v188, v197, v185
  v_mul_f32 v190, v199, v185
  v_mul_f32 v193, v200, v185
  v_mul_f32 v206, v41, v173
  v_mul_f32 v209, v42, v177
  v_mul_f32 v49, v10, v181
  v_mul_f32 v186, v195, v185
  s_barrier
  v_mul_f32 v189, v196, v185
  v_mul_f32 v191, v198, v185
  v_fma_f32 v200, v200, v184, -v192
  v_mul_f32 v207, v40, v173
  v_fma_f32 v42, v42, v176, -v208
  v_fma_f32 v46, v10, v180, -v48
  v_mul_f32 v187, v194, v185
  v_fma_f32 v196, v196, v184, -v188
  v_fma_f32 v198, v198, v184, -v190
  v_fma_f32 v201, v201, v184, v193
  v_fma_f32 v40, v40, v172, -v206
  v_fma_f32 v43, v43, v176, v209
  v_fma_f32 v47, v11, v180, v49
  v_fma_f32 v194, v194, v184, -v186
  v_fma_f32 v197, v197, v184, v189
  v_fma_f32 v199, v199, v184, v191
  v_cvt_pk_bf16_f32 v157, v200, v201
  v_fma_f32 v41, v41, v172, v207
  v_cvt_pk_bf16_f32 v134, v42, -v43
  v_cvt_pk_bf16_f32 v127, v46, -v47
  v_fma_f32 v195, v195, v184, v187
  v_cvt_pk_bf16_f32 v159, v196, v197
  v_cvt_pk_bf16_f32 v160, v198, v199
  v_mul_f32 v192, v201, v185
  v_cvt_pk_bf16_f32 v122, v40, -v41
  v_mul_f32 v208, v43, v177
  v_mul_f32 v48, v47, v179
  v_cvt_pk_bf16_f32 v162, v194, v195
  v_mul_f32 v188, v197, v185
  v_mul_f32 v190, v199, v185
  v_mul_f32 v193, v200, v185
  v_mul_f32 v206, v41, v173
  v_mul_f32 v209, v42, v177
  v_mul_f32 v49, v46, v179
  v_mul_f32 v186, v195, v185
  v_mul_f32 v189, v196, v185
  v_mul_f32 v191, v198, v185
  v_fma_f32 v200, v200, v184, -v192
  v_mul_f32 v207, v40, v173
  v_fma_f32 v42, v42, v176, -v208
  v_fma_f32 v44, v46, v178, -v48
  v_mul_f32 v187, v194, v185
  v_fma_f32 v196, v196, v184, -v188
  v_fma_f32 v198, v198, v184, -v190
  v_fma_f32 v201, v201, v184, v193
  v_fma_f32 v40, v40, v172, -v206
  v_fma_f32 v43, v43, v176, v209
  v_fma_f32 v45, v47, v178, v49
  v_fma_f32 v194, v194, v184, -v186
  v_fma_f32 v197, v197, v184, v189
  v_fma_f32 v199, v199, v184, v191
  v_cvt_pk_bf16_f32 v161, v200, v201
  v_fma_f32 v41, v41, v172, v207
  v_cvt_pk_bf16_f32 v135, v42, -v43
  v_cvt_pk_bf16_f32 v128, v44, -v45
  v_fma_f32 v195, v195, v184, v187
  v_cvt_pk_bf16_f32 v163, v196, v197
  v_cvt_pk_bf16_f32 v164, v198, v199
  v_mul_f32 v192, v201, v185
  v_cvt_pk_bf16_f32 v123, v40, -v41
  v_mul_f32 v208, v43, v177
  v_mul_f32 v48, v13, v181
  v_cvt_pk_bf16_f32 v166, v194, v195
  v_mul_f32 v188, v197, v185
  s_barrier
  v_mul_f32 v190, v199, v185
  v_mul_f32 v193, v200, v185
  v_mul_f32 v206, v41, v173
  v_mul_f32 v209, v42, v177
  v_mul_f32 v49, v12, v181
  v_mul_f32 v189, v196, v185
  v_mul_f32 v191, v198, v185
  v_fma_f32 v200, v200, v184, -v192
  v_mul_f32 v207, v40, v173
  v_fma_f32 v42, v42, v176, -v208
  v_fma_f32 v46, v12, v180, -v48
  v_fma_f32 v196, v196, v184, -v188
  v_fma_f32 v198, v198, v184, -v190
  v_fma_f32 v201, v201, v184, v193
  v_fma_f32 v40, v40, v172, -v206
  v_fma_f32 v43, v43, v176, v209
  v_fma_f32 v47, v13, v180, v49
  v_fma_f32 v197, v197, v184, v189
  v_fma_f32 v199, v199, v184, v191
  v_cvt_pk_bf16_f32 v165, v200, v201
  v_fma_f32 v41, v41, v172, v207
  v_cvt_pk_bf16_f32 v136, v42, -v43
  v_cvt_pk_bf16_f32 v130, v46, -v47
  v_cvt_pk_bf16_f32 v167, v196, v197
  v_cvt_pk_bf16_f32 v168, v198, v199
  v_mul_f32 v192, v201, v185
  v_cvt_pk_bf16_f32 v124, v40, -v41
  v_mul_f32 v208, v43, v177
  v_mul_f32 v48, v19, v181
  v_mul_f32 v193, v200, v185
  v_mul_f32 v209, v42, v177
  v_mul_f32 v49, v18, v181
  v_fma_f32 v200, v200, v184, -v192
  v_fma_f32 v42, v42, v176, -v208
  v_fma_f32 v44, v18, v180, -v48
  v_fma_f32 v201, v201, v184, v193
  v_fma_f32 v43, v43, v176, v209
  v_fma_f32 v45, v19, v180, v49
  v_cvt_pk_bf16_f32 v169, v200, v201
  v_cvt_pk_bf16_f32 v137, v42, -v43
  v_cvt_pk_bf16_f32 v132, v44, -v45
  s_lshl_b32 s58, s38, 16
  v_mov_b32 v204, s58
  v_mul_f32 v204, 1069066811, v204
  v_exp_f32 v204, v204
  v_lshlrev_b32 v202, 16, v240
  v_lshlrev_b32 v203, 16, v241
  v_lshlrev_b32 v170, 16, v242
  v_lshlrev_b32 v171, 16, v243
  v_cvt_pk_bf16_f32 v204, v204, v204
  v_mul_f32 v202, 1069066811, v202
  v_exp_f32 v202, v202
  v_and_b32 v204, 0xffff0000, v204
  v_mul_f32 v203, v203, v204
  v_cvt_pk_bf16_f32 v202, v202, v202
  v_and_b32 v202, 0xffff0000, v202
  s_barrier
  s_waitcnt vmcnt(0)
  v_mov_b32 v2, s59
  v_mov_b32 v3, s20
  s_mov_b64 exec, 1
  buffer_store_dword v3, v2, s[16:19], 0 offen sc1
  s_mov_b64 exec, -1
  v_mul_f32 v202, v202, v204
  v_mul_f32 v202, 3216550459, v202
  v_mul_f32 v203, 1042479491, v203
  v_add_f32 v204, v204, v204
  v_mul_f32 v170, v170, v204
  v_mul_f32 v171, v171, v204
  v_mul_f32 v206, 1065353216, v202
  v_mul_f32 v207, 1065353216, v203
  v_exp_f32 v206, v206
  v_fract_f32 v207, v207
  v_cos_f32 v208, v207
  v_sin_f32 v209, v207
  v_mul_f32 v172, v206, v208
  v_mul_f32 v173, v206, v209
  v_mul_f32 v206, 1090519040, v202
  v_mul_f32 v207, 1090519040, v203
  v_exp_f32 v206, v206
  v_fract_f32 v207, v207
  v_cos_f32 v208, v207
  v_sin_f32 v209, v207
  v_mul_f32 v174, v206, v208
  v_mul_f32 v175, v206, v209
  v_mul_f32 v206, 1132462080, v202
  v_mul_f32 v207, 1132462080, v203
  v_exp_f32 v206, v206
  v_fract_f32 v207, v207
  v_cos_f32 v208, v207
  s_barrier
  v_sin_f32 v209, v207
  v_mul_f32 v176, v206, v208
  v_mul_f32 v177, v206, v209
  v_mul_f32 v206, v173, v173
  v_mul_f32 v207, v172, v173
  v_fma_f32 v178, v172, v172, -v206
  v_fma_f32 v179, v173, v172, v207
  v_mul_f32 v208, v175, v175
  v_mul_f32 v209, v174, v175
  v_fma_f32 v182, v174, v174, -v208
  v_fma_f32 v183, v175, v174, v209
  v_mul_f32 v206, v179, v179
  v_mul_f32 v207, v178, v179
  v_fma_f32 v180, v178, v178, -v206
  v_fma_f32 v181, v179, v178, v207
  v_mul_f32 v208, v183, v183
  v_mul_f32 v209, v182, v183
  v_fma_f32 v184, v182, v182, -v208
  v_fma_f32 v185, v183, v182, v209
  v_mov_b32 v85, 0x3f80
  v_cvt_pk_bf16_f32 v86, v174, v175
  v_cvt_pk_bf16_f32 v87, v182, v183
  v_mul_f32 v192, v183, v175
  v_cvt_pk_bf16_f32 v64, v170, -v171
  v_mul_f32 v208, v171, v177
  v_cvt_pk_bf16_f32 v89, v184, v185
  v_mul_f32 v188, v175, v185
  v_mul_f32 v190, v183, v185
  v_mul_f32 v193, v182, v175
  v_mul_f32 v206, v171, v173
  v_mul_f32 v209, v170, v177
  s_barrier
  v_mul_f32 v186, v185, v185
  v_mul_f32 v189, v174, v185
  v_mul_f32 v191, v182, v185
  v_fma_f32 v200, v182, v174, -v192
  v_mul_f32 v207, v170, v173
  v_fma_f32 v10, v170, v176, -v208
  v_mul_f32 v187, v184, v185
  v_fma_f32 v196, v174, v184, -v188
  v_fma_f32 v198, v182, v184, -v190
  v_fma_f32 v201, v183, v174, v193
  v_fma_f32 v40, v170, v172, -v206
  v_fma_f32 v11, v171, v176, v209
  v_fma_f32 v194, v184, v184, -v186
  v_fma_f32 v197, v175, v184, v189
  v_fma_f32 v199, v183, v184, v191
  v_cvt_pk_bf16_f32 v88, v200, v201
  v_fma_f32 v41, v171, v172, v207
  v_cvt_pk_bf16_f32 v72, v10, -v11
  v_fma_f32 v195, v185, v184, v187
  v_cvt_pk_bf16_f32 v90, v196, v197
  v_cvt_pk_bf16_f32 v91, v198, v199
  v_mul_f32 v192, v201, v185
  v_cvt_pk_bf16_f32 v65, v40, -v41
  v_mul_f32 v208, v11, v177
  v_cvt_pk_bf16_f32 v93, v194, v195
  v_mul_f32 v188, v197, v185
  v_mul_f32 v190, v199, v185
  v_mul_f32 v193, v200, v185
  v_mul_f32 v206, v41, v173
  v_mul_f32 v209, v10, v177
  v_mul_f32 v186, v195, v185
  v_mul_f32 v189, v196, v185
  v_mul_f32 v191, v198, v185
  v_fma_f32 v200, v200, v184, -v192
  v_mul_f32 v207, v40, v173
  v_fma_f32 v12, v10, v176, -v208
  v_mul_f32 v187, v194, v185
  v_fma_f32 v196, v196, v184, -v188
  v_fma_f32 v198, v198, v184, -v190
  v_fma_f32 v201, v201, v184, v193
  v_fma_f32 v40, v40, v172, -v206
  v_fma_f32 v13, v11, v176, v209
  v_fma_f32 v194, v194, v184, -v186
  s_barrier
  v_fma_f32 v197, v197, v184, v189
  v_fma_f32 v199, v199, v184, v191
  v_cvt_pk_bf16_f32 v92, v200, v201
  v_fma_f32 v41, v41, v172, v207
  v_cvt_pk_bf16_f32 v76, v12, -v13
  v_fma_f32 v195, v195, v184, v187
  v_cvt_pk_bf16_f32 v94, v196, v197
  v_cvt_pk_bf16_f32 v95, v198, v199
  v_mul_f32 v192, v201, v185
  v_cvt_pk_bf16_f32 v66, v40, -v41
  v_mul_f32 v208, v13, v177
  v_cvt_pk_bf16_f32 v97, v194, v195
  v_mul_f32 v188, v197, v185
  v_mul_f32 v190, v199, v185
  v_mul_f32 v193, v200, v185
  v_mul_f32 v206, v41, v173
  v_mul_f32 v209, v12, v177
  v_mul_f32 v186, v195, v185
  v_mul_f32 v189, v196, v185
  v_mul_f32 v191, v198, v185
  v_fma_f32 v200, v200, v184, -v192
  v_mul_f32 v207, v40, v173
  v_fma_f32 v18, v12, v176, -v208
  v_mul_f32 v187, v194, v185
  v_fma_f32 v196, v196, v184, -v188
  v_fma_f32 v198, v198, v184, -v190
  v_fma_f32 v201, v201, v184, v193
  v_fma_f32 v40, v40, v172, -v206
  v_fma_f32 v19, v13, v176, v209
  v_fma_f32 v194, v194, v184, -v186
  v_fma_f32 v197, v197, v184, v189
  v_fma_f32 v199, v199, v184, v191
  v_cvt_pk_bf16_f32 v96, v200, v201
  v_fma_f32 v41, v41, v172, v207
  v_cvt_pk_bf16_f32 v78, v18, -v19
  v_fma_f32 v195, v195, v184, v187
  v_cvt_pk_bf16_f32 v98, v196, v197
  v_cvt_pk_bf16_f32 v99, v198, v199
  v_mul_f32 v192, v201, v185
  v_cvt_pk_bf16_f32 v67, v40, -v41
  v_mul_f32 v208, v19, v177
  v_mul_f32 v48, v11, v179
  v_cvt_pk_bf16_f32 v101, v194, v195
  s_barrier
  v_mul_f32 v188, v197, v185
  v_mul_f32 v190, v199, v185
  v_mul_f32 v193, v200, v185
  v_mul_f32 v206, v41, v173
  v_mul_f32 v209, v18, v177
  v_mul_f32 v49, v10, v179
  v_mul_f32 v186, v195, v185
  v_mul_f32 v189, v196, v185
  v_mul_f32 v191, v198, v185
  v_fma_f32 v200, v200, v184, -v192
  v_mul_f32 v207, v40, v173
  v_fma_f32 v42, v18, v176, -v208
  v_fma_f32 v44, v10, v178, -v48
  v_mul_f32 v187, v194, v185
  v_fma_f32 v196, v196, v184, -v188
  v_fma_f32 v198, v198, v184, -v190
  v_fma_f32 v201, v201, v184, v193
  v_fma_f32 v40, v40, v172, -v206
  v_fma_f32 v43, v19, v176, v209
  v_fma_f32 v45, v11, v178, v49
  v_fma_f32 v194, v194, v184, -v186
  v_fma_f32 v197, v197, v184, v189
  v_fma_f32 v199, v199, v184, v191
  v_cvt_pk_bf16_f32 v100, v200, v201
  v_fma_f32 v41, v41, v172, v207
  v_cvt_pk_bf16_f32 v80, v42, -v43
  v_cvt_pk_bf16_f32 v73, v44, -v45
  v_fma_f32 v195, v195, v184, v187
  v_cvt_pk_bf16_f32 v102, v196, v197
  v_cvt_pk_bf16_f32 v103, v198, v199
  v_mul_f32 v192, v201, v185
  v_cvt_pk_bf16_f32 v68, v40, -v41
  v_mul_f32 v208, v43, v177
  v_mul_f32 v48, v11, v181
  v_cvt_pk_bf16_f32 v105, v194, v195
  v_mul_f32 v188, v197, v185
  v_mul_f32 v190, v199, v185
  v_mul_f32 v193, v200, v185
  v_mul_f32 v206, v41, v173
  v_mul_f32 v209, v42, v177
  v_mul_f32 v49, v10, v181
  v_mul_f32 v186, v195, v185
  s_barrier
  v_mul_f32 v189, v196, v185
  v_mul_f32 v191, v198, v185
  v_fma_f32 v200, v200, v184, -v192
  v_mul_f32 v207, v40, v173
  v_fma_f32 v42, v42, v176, -v208
  v_fma_f32 v46, v10, v180, -v48
  v_mul_f32 v187, v194, v185
  v_fma_f32 v196, v196, v184, -v188
  v_fma_f32 v198, v198, v184, -v190
  v_fma_f32 v201, v201, v184, v193
  v_fma_f32 v40, v40, v172, -v206
  v_fma_f32 v43, v43, v176, v209
  v_fma_f32 v47, v11, v180, v49
  v_fma_f32 v194, v194, v184, -v186
  v_fma_f32 v197, v197, v184, v189
  v_fma_f32 v199, v199, v184, v191
  v_cvt_pk_bf16_f32 v104, v200, v201
  v_fma_f32 v41, v41, v172, v207
  v_cvt_pk_bf16_f32 v81, v42, -v43
  v_cvt_pk_bf16_f32 v74, v46, -v47
  v_fma_f32 v195, v195, v184, v187
  v_cvt_pk_bf16_f32 v106, v196, v197
  v_cvt_pk_bf16_f32 v107, v198, v199
  v_mul_f32 v192, v201, v185
  v_cvt_pk_bf16_f32 v69, v40, -v41
  v_mul_f32 v208, v43, v177
  v_mul_f32 v48, v47, v179
  v_cvt_pk_bf16_f32 v109, v194, v195
  v_mul_f32 v188, v197, v185
  v_mul_f32 v190, v199, v185
  v_mul_f32 v193, v200, v185
  v_mul_f32 v206, v41, v173
  v_mul_f32 v209, v42, v177
  v_mul_f32 v49, v46, v179
  v_mul_f32 v186, v195, v185
  v_mul_f32 v189, v196, v185
  v_mul_f32 v191, v198, v185
  v_fma_f32 v200, v200, v184, -v192
  v_mul_f32 v207, v40, v173
  v_fma_f32 v42, v42, v176, -v208
  v_fma_f32 v44, v46, v178, -v48
  v_mul_f32 v187, v194, v185
  s_barrier
  v_fma_f32 v196, v196, v184, -v188
  v_fma_f32 v198, v198, v184, -v190
  v_fma_f32 v201, v201, v184, v193
  v_fma_f32 v40, v40, v172, -v206
  v_fma_f32 v43, v43, v176, v209
  v_fma_f32 v45, v47, v178, v49
  v_fma_f32 v194, v194, v184, -v186
  v_fma_f32 v197, v197, v184, v189
  v_fma_f32 v199, v199, v184, v191
  v_cvt_pk_bf16_f32 v108, v200, v201
  v_fma_f32 v41, v41, v172, v207
  v_cvt_pk_bf16_f32 v82, v42, -v43
  v_cvt_pk_bf16_f32 v75, v44, -v45
  v_fma_f32 v195, v195, v184, v187
  v_cvt_pk_bf16_f32 v110, v196, v197
  v_cvt_pk_bf16_f32 v111, v198, v199
  v_mul_f32 v192, v201, v185
  v_cvt_pk_bf16_f32 v70, v40, -v41
  v_mul_f32 v208, v43, v177
  v_mul_f32 v48, v13, v181
  v_cvt_pk_bf16_f32 v113, v194, v195
  v_mul_f32 v188, v197, v185
  v_mul_f32 v190, v199, v185
  v_mul_f32 v193, v200, v185
  v_mul_f32 v206, v41, v173
  v_mul_f32 v209, v42, v177
  v_mul_f32 v49, v12, v181
  v_mul_f32 v189, v196, v185
  v_mul_f32 v191, v198, v185
  v_fma_f32 v200, v200, v184, -v192
  v_mul_f32 v207, v40, v173
  v_fma_f32 v42, v42, v176, -v208
  v_fma_f32 v46, v12, v180, -v48
  v_fma_f32 v196, v196, v184, -v188
  v_fma_f32 v198, v198, v184, -v190
  v_fma_f32 v201, v201, v184, v193
  v_fma_f32 v40, v40, v172, -v206
  v_fma_f32 v43, v43, v176, v209
  v_fma_f32 v47, v13, v180, v49
  v_fma_f32 v197, v197, v184, v189
  v_fma_f32 v199, v199, v184, v191
  v_cvt_pk_bf16_f32 v112, v200, v201
  v_fma_f32 v41, v41, v172, v207
  v_cvt_pk_bf16_f32 v83, v42, -v43
  v_cvt_pk_bf16_f32 v77, v46, -v47
  v_cvt_pk_bf16_f32 v114, v196, v197
  v_cvt_pk_bf16_f32 v115, v198, v199
  v_mul_f32 v192, v201, v185
  v_cvt_pk_bf16_f32 v71, v40, -v41
  v_mul_f32 v208, v43, v177
  v_mul_f32 v48, v19, v181
  v_mul_f32 v193, v200, v185
  v_mul_f32 v209, v42, v177
  v_mul_f32 v49, v18, v181
  v_fma_f32 v200, v200, v184, -v192
  v_fma_f32 v42, v42, v176, -v208
  v_fma_f32 v44, v18, v180, -v48
  v_fma_f32 v201, v201, v184, v193
  v_fma_f32 v43, v43, v176, v209
  v_fma_f32 v45, v19, v180, v49
  v_cvt_pk_bf16_f32 v116, v200, v201
  v_cvt_pk_bf16_f32 v84, v42, -v43
  v_cvt_pk_bf16_f32 v79, v44, -v45
  s_mov_b64 exec, 1
  ds_write_b32 v250, v253 offset:8
  s_mov_b64 exec, -1
  s_cmp_eq_u32 s3, 4
  s_cselect_b32 s60, 1, 0
  s_cbranch_scc0 Q_nof0a
  buffer_load_dwordx4 v[28:31], v223, s[16:19], 0 offen sc1
Q_nof0a:
  ds_write_addtid_b32 v117 offset:0
  ds_write_addtid_b32 v118 offset:1056
  ds_write_addtid_b32 v119 offset:2112
  ds_write_addtid_b32 v120 offset:3168
  ds_write_addtid_b32 v121 offset:4224
  ds_write_addtid_b32 v122 offset:5280
  ds_write_addtid_b32 v123 offset:6336
  ds_write_addtid_b32 v124 offset:7392
  ds_write_addtid_b32 v125 offset:8448
  ds_write_addtid_b32 v126 offset:9504
  ds_write_addtid_b32 v127 offset:10560
  ds_write_addtid_b32 v128 offset:11616
  ds_write_addtid_b32 v129 offset:12672
  ds_write_addtid_b32 v130 offset:13728
  ds_write_addtid_b32 v131 offset:14784
  ds_write_addtid_b32 v132 offset:15840
  ds_write_addtid_b32 v133 offset:16896
  ds_write_addtid_b32 v134 offset:17952
  ds_write_addtid_b32 v135 offset:19008
  ds_write_addtid_b32 v136 offset:20064
  ds_write_addtid_b32 v137 offset:21120
  ds_write_addtid_b32 v138 offset:22176
  ds_write_addtid_b32 v139 offset:23232
  ds_write_addtid_b32 v140 offset:24288
  ds_write_addtid_b32 v141 offset:25344
  ds_write_addtid_b32 v142 offset:26400
  ds_write_addtid_b32 v143 offset:27456
  ds_write_addtid_b32 v144 offset:28512
  ds_write_addtid_b32 v145 offset:29568
  ds_write_addtid_b32 v146 offset:30624
  ds_write_addtid_b32 v147 offset:31680
  ds_write_addtid_b32 v148 offset:32736
  ds_write_addtid_b32 v149 offset:33792
  ds_write_addtid_b32 v150 offset:34848
  ds_write_addtid_b32 v151 offset:35904
  ds_write_addtid_b32 v152 offset:36960
  ds_write_addtid_b32 v153 offset:38016
  ds_write_addtid_b32 v154 offset:39072
  ds_write_addtid_b32 v155 offset:40128
  ds_write_addtid_b32 v156 offset:41184
  ds_write_addtid_b32 v157 offset:42240
  ds_write_addtid_b32 v158 offset:43296
  ds_write_addtid_b32 v159 offset:44352
  ds_write_addtid_b32 v160 offset:45408
  ds_write_addtid_b32 v161 offset:46464
  ds_write_addtid_b32 v162 offset:47520
  ds_write_addtid_b32 v163 offset:48576
  ds_write_addtid_b32 v164 offset:49632
  ds_write_addtid_b32 v165 offset:50688
  ds_write_addtid_b32 v166 offset:51744
  ds_write_addtid_b32 v167 offset:52800
  ds_write_addtid_b32 v168 offset:53856
  ds_write_addtid_b32 v169 offset:54912
  s_lshl_b32 s36, s29, 8
  s_add_u32 m0, s36, 55968
  s_nop 0
  ds_write_addtid_b32 v64 offset:0
  ds_write_addtid_b32 v65 offset:1056
  ds_write_addtid_b32 v66 offset:2112
  ds_write_addtid_b32 v67 offset:3168
  ds_write_addtid_b32 v68 offset:4224
  ds_write_addtid_b32 v69 offset:5280
  ds_write_addtid_b32 v70 offset:6336
  ds_write_addtid_b32 v71 offset:7392
  ds_write_addtid_b32 v72 offset:8448
  ds_write_addtid_b32 v73 offset:9504
  ds_write_addtid_b32 v74 offset:10560
  ds_write_addtid_b32 v75 offset:11616
  ds_write_addtid_b32 v76 offset:12672
  ds_write_addtid_b32 v77 offset:13728
  ds_write_addtid_b32 v78 offset:14784
  ds_write_addtid_b32 v79 offset:15840
  ds_write_addtid_b32 v80 offset:16896
  ds_write_addtid_b32 v81 offset:17952
  ds_write_addtid_b32 v82 offset:19008
  ds_write_addtid_b32 v83 offset:20064
  ds_write_addtid_b32 v84 offset:21120
  ds_write_addtid_b32 v85 offset:22176
  ds_write_addtid_b32 v86 offset:23232
  ds_write_addtid_b32 v87 offset:24288
  ds_write_addtid_b32 v88 offset:25344
  ds_write_addtid_b32 v89 offset:26400
  ds_write_addtid_b32 v90 offset:27456
  ds_write_addtid_b32 v91 offset:28512
  ds_write_addtid_b32 v92 offset:29568
  ds_write_addtid_b32 v93 offset:30624
  ds_write_addtid_b32 v94 offset:31680
  ds_write_addtid_b32 v95 offset:32736
  ds_write_addtid_b32 v96 offset:33792
  ds_write_addtid_b32 v97 offset:34848
  ds_write_addtid_b32 v98 offset:35904
  ds_write_addtid_b32 v99 offset:36960
  ds_write_addtid_b32 v100 offset:38016
  ds_write_addtid_b32 v101 offset:39072
  ds_write_addtid_b32 v102 offset:40128
  ds_write_addtid_b32 v103 offset:41184
  ds_write_addtid_b32 v104 offset:42240
  ds_write_addtid_b32 v105 offset:43296
  ds_write_addtid_b32 v106 offset:44352
  ds_write_addtid_b32 v107 offset:45408
  ds_write_addtid_b32 v108 offset:46464
  ds_write_addtid_b32 v109 offset:47520
  ds_write_addtid_b32 v110 offset:48576
  ds_write_addtid_b32 v111 offset:49632
  ds_write_addtid_b32 v112 offset:50688
  ds_write_addtid_b32 v113 offset:51744
  ds_write_addtid_b32 v114 offset:52800
  ds_write_addtid_b32 v115 offset:53856
  ds_write_addtid_b32 v116 offset:54912
  s_waitcnt lgkmcnt(0)
  s_barrier
  s_cmp_eq_u32 s60, 0
  s_cbranch_scc1 Q_lkz
  s_waitcnt vmcnt(0)
  v_xor_b32 v28, s20, v28
  v_xor_b32 v29, s20, v29
  v_xor_b32 v30, s20, v30
  v_xor_b32 v31, s20, v31
  v_or3_b32 v28, v28, v29, v30
  v_or_b32 v28, v28, v31
  v_cmp_ne_u32 vcc, 0, v28
  s_nop 4
  s_cbranch_vccz Q_lgz
  buffer_load_dwordx4 v[28:31], v223, s[16:19], 0 offen sc1
  s_branch Q_lkz
Q_lgz:
  s_call_b64 s[90:91], Q_udma
Q_lkz:
  ds_read_b128 v[112:115], v20 offset:0
  ds_read_b128 v[144:147], v21 offset:0
  ds_read_b128 v[116:119], v20 offset:64
  ds_read_b128 v[148:151], v21 offset:64
  ds_read_b128 v[120:123], v20 offset:128
  ds_read_b128 v[152:155], v21 offset:128
  ds_read_b128 v[124:127], v20 offset:192
  ds_read_b128 v[156:159], v21 offset:192
  ds_read_b128 v[128:131], v20 offset:256
  ds_read_b128 v[160:163], v21 offset:256
  ds_read_b128 v[132:135], v20 offset:320
  ds_read_b128 v[164:167], v21 offset:320
  s_waitcnt lgkmcnt(10)
  v_mfma_f32_16x16x32_bf16 v[176:179], v[112:115], v[144:147], 0
  ds_read_b128 v[136:139], v20 offset:384
  ds_read_b128 v[168:171], v21 offset:384
  s_waitcnt lgkmcnt(10)
  v_mfma_f32_16x16x32_bf16 v[176:179], v[116:119], v[148:151], v[176:179]
  ds_read_b128 v[140:143], v20 offset:448
  ds_read_b128 v[172:175], v21 offset:448
  s_waitcnt lgkmcnt(10)
  v_mfma_f32_16x16x32_bf16 v[176:179], v[120:123], v[152:155], v[176:179]
  ds_read_b128 v[112:115], v20 offset:512
  ds_read_b128 v[144:147], v21 offset:512
  s_waitcnt lgkmcnt(10)
  v_mfma_f32_16x16x32_bf16 v[176:179], v[124:127], v[156:159], v[176:179]
  ds_read_b128 v[116:119], v20 offset:576
  ds_read_b128 v[148:151], v21 offset:576
  s_waitcnt lgkmcnt(10)
  v_mfma_f32_16x16x32_bf16 v[176:179], v[128:131], v[160:163], v[176:179]
  ds_read_b128 v[120:123], v20 offset:640
  ds_read_b128 v[152:155], v21 offset:640
  s_waitcnt lgkmcnt(10)
  v_mfma_f32_16x16x32_bf16 v[176:179], v[132:135], v[164:167], v[176:179]
  ds_read_b128 v[124:127], v20 offset:704
  ds_read_b128 v[156:159], v21 offset:704
  s_waitcnt lgkmcnt(10)
  v_mfma_f32_16x16x32_bf16 v[176:179], v[136:139], v[168:171], v[176:179]
  ds_read_b128 v[128:131], v20 offset:768
  ds_read_b128 v[160:163], v21 offset:768
  s_waitcnt lgkmcnt(10)
  v_mfma_f32_16x16x32_bf16 v[176:179], v[140:143], v[172:175], v[176:179]
  ds_read_b128 v[132:135], v20 offset:832
  ds_read_b128 v[164:167], v21 offset:832
  s_waitcnt lgkmcnt(10)
  v_mfma_f32_16x16x32_bf16 v[176:179], v[112:115], v[144:147], v[176:179]
  ds_read_b128 v[136:139], v20 offset:896
  ds_read_b128 v[168:171], v21 offset:896
  s_waitcnt lgkmcnt(10)
  v_mfma_f32_16x16x32_bf16 v[176:179], v[116:119], v[148:151], v[176:179]
  ds_read_b128 v[140:143], v20 offset:960
  ds_read_b128 v[172:175], v21 offset:960
  s_waitcnt lgkmcnt(10)
  v_mfma_f32_16x16x32_bf16 v[176:179], v[120:123], v[152:155], v[176:179]
  s_waitcnt lgkmcnt(8)
  v_mfma_f32_16x16x32_bf16 v[176:179], v[124:127], v[156:159], v[176:179]
  s_waitcnt lgkmcnt(6)
  v_mfma_f32_16x16x32_bf16 v[176:179], v[128:131], v[160:163], v[176:179]
  s_waitcnt lgkmcnt(4)
  v_mfma_f32_16x16x32_bf16 v[176:179], v[132:135], v[164:167], v[176:179]
  s_waitcnt lgkmcnt(2)
  v_mfma_f32_16x16x32_bf16 v[176:179], v[136:139], v[168:171], v[176:179]
  s_waitcnt lgkmcnt(0)
  v_mfma_f32_16x16x32_bf16 v[176:179], v[140:143], v[172:175], v[176:179]
  ds_write_b16 v26, v32
  s_nop 6
  v_add_f32 v176, v176, v27
  v_cvt_pk_bf16_f32 v180, v176, v177
  v_cvt_pk_bf16_f32 v181, v178, v179
  ds_write_b16 v22, v180
  ds_write_b16_d16_hi v23, v180
  ds_write_b16 v24, v181
  ds_write_b16_d16_hi v25, v181
  s_waitcnt lgkmcnt(0)
  s_barrier
  s_cmp_eq_u32 s60, 0
  s_cbranch_scc1 Q_lkb
  s_waitcnt vmcnt(0)
  v_xor_b32 v28, s20, v28
  v_xor_b32 v29, s20, v29
  v_xor_b32 v30, s20, v30
  v_xor_b32 v31, s20, v31
  v_or3_b32 v28, v28, v29, v30
  v_or_b32 v28, v28, v31
  v_cmp_ne_u32 vcc, 0, v28
  s_nop 4
  s_cbranch_vccz Q_lgb
  buffer_load_dwordx4 v[28:31], v223, s[16:19], 0 offen sc1
  s_branch Q_lkb
Q_lgb:
  s_call_b64 s[90:91], Q_udma
Q_lkb:
  s_mov_b32 exec_hi, 0
  ds_write_b128 v217, v[32:35]
  s_mov_b32 exec_hi, -1
  ds_read_u16 v64, v224 offset:5248
  ds_read_u16 v65, v225 offset:5248
  ds_read_u16 v66, v226 offset:5248
  ds_read_u16 v67, v227 offset:5248
  ds_read_u16 v68, v228 offset:5248
  ds_read_u16 v69, v229 offset:5248
  ds_read_u16 v70, v230 offset:5248
  ds_read_u16 v71, v231 offset:5248
  ds_read_u16 v72, v232 offset:5248
  ds_read_u16 v73, v233 offset:5248
  ds_read_u16 v74, v234 offset:5248
  s_waitcnt lgkmcnt(0)
  v_lshl_or_b32 v80, v65, 16, v64
  v_lshl_or_b32 v81, v67, 16, v66
  v_lshl_or_b32 v82, v69, 16, v68
  v_lshl_or_b32 v83, v71, 16, v70
  ds_write_b128 v249, v[80:83] offset:4160
  v_lshl_or_b32 v84, v66, 16, v65
  v_lshl_or_b32 v85, v68, 16, v67
  v_lshl_or_b32 v86, v70, 16, v69
  v_lshl_or_b32 v87, v72, 16, v71
  ds_write_b128 v249, v[84:87] offset:12544
  v_lshl_or_b32 v88, v67, 16, v66
  v_lshl_or_b32 v89, v69, 16, v68
  v_lshl_or_b32 v90, v71, 16, v70
  v_lshl_or_b32 v91, v73, 16, v72
  ds_write_b128 v249, v[88:91] offset:20928
  v_lshl_or_b32 v92, v68, 16, v67
  v_lshl_or_b32 v93, v70, 16, v69
  v_lshl_or_b32 v94, v72, 16, v71
  v_lshl_or_b32 v95, v74, 16, v73
  ds_write_b128 v249, v[92:95] offset:29312
  v_mov_b32 v249, 97280
  ds_write_b32 v249, v32
  s_cmp_lg_u32 s3, 4
  s_cbranch_scc1 Q_u0
  s_cmp_lg_u32 s60, 0
  s_cbranch_scc1 Q_u0
  s_waitcnt vmcnt(0)
  ds_write_b32 v250, v251
Q_u0:
  s_waitcnt lgkmcnt(0)
  s_barrier
  s_cmp_eq_u32 s60, 0
  s_cbranch_scc1 Q_uw
  s_cmp_eq_u32 s60, 0
  s_cbranch_scc1 Q_lkc
  s_mov_b32 s62, 0
PL_f0:
  buffer_load_dwordx4 v[28:31], v223, s[16:19], 0 offen sc1
  s_waitcnt vmcnt(0)
  v_xor_b32 v28, s20, v28
  v_xor_b32 v29, s20, v29
  v_xor_b32 v30, s20, v30
  v_xor_b32 v31, s20, v31
  v_or3_b32 v28, v28, v29, v30
  v_or_b32 v28, v28, v31
  v_cmp_ne_u32 vcc, 0, v28
  s_nop 4
  s_cbranch_vccz PL_f0_ok
  s_sleep 1
  s_add_u32 s62, s62, 1
  s_cmp_lt_u32 s62, 1000000
  s_cbranch_scc1 PL_f0
PL_f0_ok:
  s_mov_b64 exec, -1
  s_call_b64 s[90:91], Q_udma
Q_lkc:
  s_waitcnt vmcnt(0)
  ds_write_b32 v250, v251
Q_uw:
GW2:
  ds_read_b32 v2, v250 offset:0
  s_waitcnt lgkmcnt(0)
  v_readfirstlane_b32 s62, v2
  s_nop 0
  s_cmp_ge_u32 s62, 1
  s_cbranch_scc1 GW2_ok
  s_sleep 1
  s_add_u32 s95, s95, 1
  s_cmp_lt_u32 s95, 0x2000000
  s_cbranch_scc1 GW2
GW2_ok:
  ds_read_b64 v[32:33], v218 offset:3040
  ds_read_b64 v[34:35], v218 offset:3048
  ds_read_b128 v[36:39], v219 offset:1232
  ds_read_b128 v[40:43], v219 offset:3792
  ds_read_b64 v[44:45], v218 offset:992
  ds_read_b64 v[46:47], v218 offset:1000
  ds_read_b64 v[48:49], v218 offset:3008
  ds_read_b64 v[50:51], v218 offset:3016
  ds_read_b128 v[52:55], v219 offset:1200
  ds_read_b128 v[56:59], v219 offset:3760
  ds_read_b64 v[60:61], v218 offset:960
  ds_read_b64 v[62:63], v218 offset:968
  s_waitcnt lgkmcnt(6)
  v_mfma_f32_32x32x16_bf16 v[176:191], v[32:35], v[36:39], 0
  ds_read_b64 v[64:65], v218 offset:2976
  ds_read_b64 v[66:67], v218 offset:2984
  s_lshl_b32 s36, s29, 12
  v_mfma_f32_32x32x16_bf16 v[192:207], v[32:35], v[40:43], 0
  ds_read_b128 v[68:71], v219 offset:1152
  ds_read_b128 v[72:75], v219 offset:3712
  s_add_u32 s36, s36, 49152
  v_mfma_f32_32x32x16_bf16 v[192:207], v[44:47], v[36:39], v[192:207]
  ds_read_b64 v[76:77], v218 offset:928
  ds_read_b64 v[78:79], v218 offset:936
  v_lshl_add_u32 v216, v1, 4, s36
  s_waitcnt lgkmcnt(6)
  v_mfma_f32_32x32x16_bf16 v[176:191], v[48:51], v[52:55], v[176:191]
  ds_read_b64 v[80:81], v218 offset:2944
  ds_read_b64 v[82:83], v218 offset:2952
  s_xor_b32 s36, s36, 8192
  v_mfma_f32_32x32x16_bf16 v[192:207], v[48:51], v[56:59], v[192:207]
  ds_read_b128 v[84:87], v219 offset:1120
  ds_read_b128 v[88:91], v219 offset:3680
  v_lshl_add_u32 v217, v1, 4, s36
  v_mfma_f32_32x32x16_bf16 v[192:207], v[60:63], v[52:55], v[192:207]
  ds_read_b64 v[92:93], v218 offset:896
  ds_read_b64 v[94:95], v218 offset:904
  s_lshl_b32 s36, s21, 13
  s_waitcnt lgkmcnt(6)
  v_mfma_f32_32x32x16_bf16 v[176:191], v[64:67], v[68:71], v[176:191]
  ds_read_b64 v[32:33], v218 offset:2912
  ds_read_b64 v[34:35], v218 offset:2920
  s_lshl_b32 s60, s61, 12
  v_mfma_f32_32x32x16_bf16 v[192:207], v[64:67], v[72:75], v[192:207]
  ds_read_b128 v[36:39], v219 offset:1072
  ds_read_b128 v[40:43], v219 offset:3632
  s_add_u32 s36, s36, s60
  v_mfma_f32_32x32x16_bf16 v[192:207], v[76:79], v[68:71], v[192:207]
  ds_read_b64 v[44:45], v218 offset:864
  ds_read_b64 v[46:47], v218 offset:872
  s_lshl_b32 s60, s63, 11
  s_waitcnt lgkmcnt(6)
  v_mfma_f32_32x32x16_bf16 v[176:191], v[80:83], v[84:87], v[176:191]
  ds_read_b64 v[48:49], v218 offset:2880
  ds_read_b64 v[50:51], v218 offset:2888
  s_add_u32 s36, s36, s60
  v_mfma_f32_32x32x16_bf16 v[192:207], v[80:83], v[88:91], v[192:207]
  ds_read_b128 v[52:55], v219 offset:1040
  ds_read_b128 v[56:59], v219 offset:3600
  s_add_u32 s36, s36, 9568256
  v_mfma_f32_32x32x16_bf16 v[192:207], v[92:95], v[84:87], v[192:207]
  ds_read_b64 v[60:61], v218 offset:832
  ds_read_b64 v[62:63], v218 offset:840
  v_and_b32 v220, 31, v1
  s_waitcnt lgkmcnt(6)
  v_mfma_f32_32x32x16_bf16 v[176:191], v[32:35], v[36:39], v[176:191]
  ds_read_b64 v[64:65], v218 offset:2848
  ds_read_b64 v[66:67], v218 offset:2856
  v_lshrrev_b32 v221, 5, v1
  v_mfma_f32_32x32x16_bf16 v[192:207], v[32:35], v[40:43], v[192:207]
  ds_read_b128 v[68:71], v219 offset:992
  ds_read_b128 v[72:75], v219 offset:3552
  v_lshlrev_b32 v220, 6, v220
  v_mfma_f32_32x32x16_bf16 v[192:207], v[44:47], v[36:39], v[192:207]
  ds_read_b64 v[76:77], v218 offset:800
  ds_read_b64 v[78:79], v218 offset:808
  v_lshl_add_u32 v220, v221, 4, v220
  s_waitcnt lgkmcnt(6)
  v_mfma_f32_32x32x16_bf16 v[176:191], v[48:51], v[52:55], v[176:191]
  ds_read_b64 v[80:81], v218 offset:2816
  ds_read_b64 v[82:83], v218 offset:2824
  v_add_u32 v220, s36, v220
  v_mfma_f32_32x32x16_bf16 v[192:207], v[48:51], v[56:59], v[192:207]
  ds_read_b128 v[84:87], v219 offset:960
  ds_read_b128 v[88:91], v219 offset:3520
  s_mov_b32 s60, s63
  v_mfma_f32_32x32x16_bf16 v[192:207], v[60:63], v[52:55], v[192:207]
  ds_read_b64 v[92:93], v218 offset:768
  ds_read_b64 v[94:95], v218 offset:776
  v_lshl_add_u32 v3, v1, 4, s96
  s_waitcnt lgkmcnt(6)
  v_mfma_f32_32x32x16_bf16 v[176:191], v[64:67], v[68:71], v[176:191]
  ds_read_b64 v[32:33], v218 offset:2784
  ds_read_b64 v[34:35], v218 offset:2792
  v_and_b32 v5, 31, v1
  v_mfma_f32_32x32x16_bf16 v[192:207], v[64:67], v[72:75], v[192:207]
  ds_read_b128 v[36:39], v219 offset:912
  ds_read_b128 v[40:43], v219 offset:3472
  v_lshrrev_b32 v6, 5, v1
  v_mfma_f32_32x32x16_bf16 v[192:207], v[76:79], v[68:71], v[192:207]
  ds_read_b64 v[44:45], v218 offset:736
  ds_read_b64 v[46:47], v218 offset:744
  v_mul_u32_u24 v4, 7168, v6
  s_waitcnt lgkmcnt(6)
  v_mfma_f32_32x32x16_bf16 v[176:191], v[80:83], v[84:87], v[176:191]
  ds_read_b64 v[48:49], v218 offset:2752
  ds_read_b64 v[50:51], v218 offset:2760
  v_lshl_add_u32 v4, v5, 4, v4
  v_mfma_f32_32x32x16_bf16 v[192:207], v[80:83], v[88:91], v[192:207]
  ds_read_b128 v[52:55], v219 offset:880
  ds_read_b128 v[56:59], v219 offset:3440
  v_add_u32 v4, s97, v4
  v_mfma_f32_32x32x16_bf16 v[192:207], v[92:95], v[84:87], v[192:207]
  ds_read_b64 v[60:61], v218 offset:704
  ds_read_b64 v[62:63], v218 offset:712
  v_add_u32 v7, 14336, v4
  s_waitcnt lgkmcnt(6)
  v_mfma_f32_32x32x16_bf16 v[176:191], v[32:35], v[36:39], v[176:191]
  ds_read_b64 v[64:65], v218 offset:2720
  ds_read_b64 v[66:67], v218 offset:2728
  v_cmp_eq_u32 vcc, 28, v5
  v_mfma_f32_32x32x16_bf16 v[192:207], v[32:35], v[40:43], v[192:207]
  ds_read_b128 v[68:71], v219 offset:832
  ds_read_b128 v[72:75], v219 offset:3392
  v_mov_b32 v12, 0x3f803f80
  v_mfma_f32_32x32x16_bf16 v[192:207], v[44:47], v[36:39], v[192:207]
  ds_read_b64 v[76:77], v218 offset:672
  ds_read_b64 v[78:79], v218 offset:680
  v_cndmask_b32 v12, 0, v12, vcc
  s_waitcnt lgkmcnt(6)
  v_mfma_f32_32x32x16_bf16 v[176:191], v[48:51], v[52:55], v[176:191]
  ds_read_b64 v[80:81], v218 offset:2688
  ds_read_b64 v[82:83], v218 offset:2696
  v_mov_b32 v13, v12
  v_mfma_f32_32x32x16_bf16 v[192:207], v[48:51], v[56:59], v[192:207]
  ds_read_b128 v[84:87], v219 offset:800
  ds_read_b128 v[88:91], v219 offset:3360
  v_mov_b64 v[144:145], v[12:13]
  v_mfma_f32_32x32x16_bf16 v[192:207], v[60:63], v[52:55], v[192:207]
  ds_read_b64 v[92:93], v218 offset:640
  ds_read_b64 v[94:95], v218 offset:648
  v_mov_b64 v[146:147], v[12:13]
  s_waitcnt lgkmcnt(6)
  v_mfma_f32_32x32x16_bf16 v[176:191], v[64:67], v[68:71], v[176:191]
  ds_read_b64 v[32:33], v218 offset:2656
  ds_read_b64 v[34:35], v218 offset:2664
  v_mov_b64 v[148:149], v[12:13]
  v_mfma_f32_32x32x16_bf16 v[192:207], v[64:67], v[72:75], v[192:207]
  ds_read_b128 v[36:39], v219 offset:752
  ds_read_b128 v[40:43], v219 offset:3312
  v_mov_b64 v[150:151], v[12:13]
  v_mfma_f32_32x32x16_bf16 v[192:207], v[76:79], v[68:71], v[192:207]
  ds_read_b64 v[44:45], v218 offset:608
  ds_read_b64 v[46:47], v218 offset:616
  v_mov_b64 v[152:153], v[12:13]
  s_waitcnt lgkmcnt(6)
  v_mfma_f32_32x32x16_bf16 v[176:191], v[80:83], v[84:87], v[176:191]
  ds_read_b64 v[48:49], v218 offset:2624
  ds_read_b64 v[50:51], v218 offset:2632
  v_mov_b64 v[154:155], v[12:13]
  v_mfma_f32_32x32x16_bf16 v[192:207], v[80:83], v[88:91], v[192:207]
  ds_read_b128 v[52:55], v219 offset:720
  ds_read_b128 v[56:59], v219 offset:3280
  v_mov_b64 v[156:157], v[12:13]
  v_mfma_f32_32x32x16_bf16 v[192:207], v[92:95], v[84:87], v[192:207]
  ds_read_b64 v[60:61], v218 offset:576
  ds_read_b64 v[62:63], v218 offset:584
  v_mov_b64 v[158:159], v[12:13]
  s_waitcnt lgkmcnt(6)
  v_mfma_f32_32x32x16_bf16 v[176:191], v[32:35], v[36:39], v[176:191]
  ds_read_b64 v[64:65], v218 offset:2592
  ds_read_b64 v[66:67], v218 offset:2600
  v_mov_b64 v[160:161], v[12:13]
  v_mfma_f32_32x32x16_bf16 v[192:207], v[32:35], v[40:43], v[192:207]
  ds_read_b128 v[68:71], v219 offset:672
  ds_read_b128 v[72:75], v219 offset:3232
  v_mov_b64 v[162:163], v[12:13]
  v_mfma_f32_32x32x16_bf16 v[192:207], v[44:47], v[36:39], v[192:207]
  ds_read_b64 v[76:77], v218 offset:544
  ds_read_b64 v[78:79], v218 offset:552
  v_mov_b64 v[164:165], v[12:13]
  s_waitcnt lgkmcnt(6)
  v_mfma_f32_32x32x16_bf16 v[176:191], v[48:51], v[52:55], v[176:191]
  ds_read_b64 v[80:81], v218 offset:2560
  ds_read_b64 v[82:83], v218 offset:2568
  v_mov_b64 v[166:167], v[12:13]
  v_mfma_f32_32x32x16_bf16 v[192:207], v[48:51], v[56:59], v[192:207]
  ds_read_b128 v[84:87], v219 offset:640
  ds_read_b128 v[88:91], v219 offset:3200
  v_mov_b64 v[168:169], v[12:13]
  v_mfma_f32_32x32x16_bf16 v[192:207], v[60:63], v[52:55], v[192:207]
  ds_read_b64 v[92:93], v218 offset:512
  ds_read_b64 v[94:95], v218 offset:520
  v_mov_b64 v[170:171], v[12:13]
  s_waitcnt lgkmcnt(6)
  v_mfma_f32_32x32x16_bf16 v[176:191], v[64:67], v[68:71], v[176:191]
  ds_read_b64 v[32:33], v218 offset:2528
  ds_read_b64 v[34:35], v218 offset:2536
  v_mov_b64 v[172:173], v[12:13]
  v_mfma_f32_32x32x16_bf16 v[192:207], v[64:67], v[72:75], v[192:207]
  ds_read_b128 v[36:39], v219 offset:592
  ds_read_b128 v[40:43], v219 offset:3152
  v_mov_b64 v[174:175], v[12:13]
  v_mfma_f32_32x32x16_bf16 v[192:207], v[76:79], v[68:71], v[192:207]
  ds_read_b64 v[44:45], v218 offset:480
  ds_read_b64 v[46:47], v218 offset:488
  v_lshrrev_b32 v8, 4, v1
  s_waitcnt lgkmcnt(6)
  v_mfma_f32_32x32x16_bf16 v[176:191], v[80:83], v[84:87], v[176:191]
  ds_read_b64 v[48:49], v218 offset:2496
  ds_read_b64 v[50:51], v218 offset:2504
  v_and_b32 v9, 15, v1
  v_mfma_f32_32x32x16_bf16 v[192:207], v[80:83], v[88:91], v[192:207]
  ds_read_b128 v[52:55], v219 offset:560
  ds_read_b128 v[56:59], v219 offset:3120
  v_lshlrev_b32 v10, 2, v8
  v_mfma_f32_32x32x16_bf16 v[192:207], v[92:95], v[84:87], v[192:207]
  ds_read_b64 v[60:61], v218 offset:448
  ds_read_b64 v[62:63], v218 offset:456
  v_xor_b32 v9, v9, v10
  s_waitcnt lgkmcnt(6)
  v_mfma_f32_32x32x16_bf16 v[176:191], v[32:35], v[36:39], v[176:191]
  ds_read_b64 v[64:65], v218 offset:2464
  ds_read_b64 v[66:67], v218 offset:2472
  v_lshlrev_b32 v9, 4, v9
  v_mfma_f32_32x32x16_bf16 v[192:207], v[32:35], v[40:43], v[192:207]
  ds_read_b128 v[68:71], v219 offset:512
  ds_read_b128 v[72:75], v219 offset:3072
  v_mul_u32_u24 v8, 896, v8
  v_mfma_f32_32x32x16_bf16 v[192:207], v[44:47], v[36:39], v[192:207]
  ds_read_b64 v[76:77], v218 offset:416
  ds_read_b64 v[78:79], v218 offset:424
  v_add_u32 v8, v8, v9
  s_waitcnt lgkmcnt(6)
  v_mfma_f32_32x32x16_bf16 v[176:191], v[48:51], v[52:55], v[176:191]
  ds_read_b64 v[80:81], v218 offset:2432
  ds_read_b64 v[82:83], v218 offset:2440
  v_add_u32 v8, s98, v8
  v_mfma_f32_32x32x16_bf16 v[192:207], v[48:51], v[56:59], v[192:207]
  ds_read_b128 v[84:87], v219 offset:480
  ds_read_b128 v[88:91], v219 offset:3040
  v_lshl_add_u32 v240, v1, 4, s5
  v_mfma_f32_32x32x16_bf16 v[192:207], v[60:63], v[52:55], v[192:207]
  ds_read_b64 v[92:93], v218 offset:384
  ds_read_b64 v[94:95], v218 offset:392
  v_lshl_add_u32 v241, v1, 4, s6
  s_waitcnt lgkmcnt(6)
  v_mfma_f32_32x32x16_bf16 v[176:191], v[64:67], v[68:71], v[176:191]
  ds_read_b64 v[32:33], v218 offset:2400
  ds_read_b64 v[34:35], v218 offset:2408
  v_lshl_add_u32 v242, v5, 4, s7
  v_mfma_f32_32x32x16_bf16 v[192:207], v[64:67], v[72:75], v[192:207]
  ds_read_b128 v[36:39], v219 offset:432
  ds_read_b128 v[40:43], v219 offset:2992
  v_lshlrev_b32 v243, 13, v6
  v_mfma_f32_32x32x16_bf16 v[192:207], v[76:79], v[68:71], v[192:207]
  ds_read_b64 v[44:45], v218 offset:352
  ds_read_b64 v[46:47], v218 offset:360
  v_lshl_add_u32 v243, v5, 4, v243
  s_waitcnt lgkmcnt(6)
  v_mfma_f32_32x32x16_bf16 v[176:191], v[80:83], v[84:87], v[176:191]
  ds_read_b64 v[48:49], v218 offset:2368
  ds_read_b64 v[50:51], v218 offset:2376
  v_add_u32 v243, 103936, v243
  v_mfma_f32_32x32x16_bf16 v[192:207], v[80:83], v[88:91], v[192:207]
  ds_read_b128 v[52:55], v219 offset:400
  ds_read_b128 v[56:59], v219 offset:2960
  v_lshl_add_u32 v238, v5, 4, s92
  v_mfma_f32_32x32x16_bf16 v[192:207], v[92:95], v[84:87], v[192:207]
  ds_read_b64 v[60:61], v218 offset:320
  ds_read_b64 v[62:63], v218 offset:328
  v_lshlrev_b32 v239, 12, v1
  s_waitcnt lgkmcnt(6)
  v_mfma_f32_32x32x16_bf16 v[176:191], v[32:35], v[36:39], v[176:191]
  ds_read_b64 v[64:65], v218 offset:2336
  ds_read_b64 v[66:67], v218 offset:2344
  v_mfma_f32_32x32x16_bf16 v[192:207], v[32:35], v[40:43], v[192:207]
  ds_read_b128 v[68:71], v219 offset:352
  ds_read_b128 v[72:75], v219 offset:2912
  v_mfma_f32_32x32x16_bf16 v[192:207], v[44:47], v[36:39], v[192:207]
  ds_read_b64 v[76:77], v218 offset:288
  ds_read_b64 v[78:79], v218 offset:296
  s_waitcnt lgkmcnt(6)
  v_mfma_f32_32x32x16_bf16 v[176:191], v[48:51], v[52:55], v[176:191]
  ds_read_b64 v[80:81], v218 offset:2304
  ds_read_b64 v[82:83], v218 offset:2312
  v_mfma_f32_32x32x16_bf16 v[192:207], v[48:51], v[56:59], v[192:207]
  ds_read_b128 v[84:87], v219 offset:320
  ds_read_b128 v[88:91], v219 offset:2880
  v_mfma_f32_32x32x16_bf16 v[192:207], v[60:63], v[52:55], v[192:207]
  ds_read_b64 v[92:93], v218 offset:256
  ds_read_b64 v[94:95], v218 offset:264
GW3:
  ds_read_b32 v2, v250 offset:12
  s_waitcnt lgkmcnt(0)
  v_readfirstlane_b32 s62, v2
  s_nop 0
  s_cmp_ge_u32 s62, 1
  s_cbranch_scc1 GW3_ok
  s_sleep 1
  s_add_u32 s95, s95, 1
  s_cmp_lt_u32 s95, 0x2000000
  s_cbranch_scc1 GW3
GW3_ok:
  v_mfma_f32_32x32x16_bf16 v[176:191], v[64:67], v[68:71], v[176:191]
  ds_read_b64 v[32:33], v218 offset:2272
  ds_read_b64 v[34:35], v218 offset:2280
  buffer_load_dwordx4 v[16:19], v3, s[16:19], s31 offen
  v_mfma_f32_32x32x16_bf16 v[192:207], v[64:67], v[72:75], v[192:207]
  ds_read_b128 v[36:39], v219 offset:272
  ds_read_b128 v[40:43], v219 offset:2832
  buffer_load_dwordx4 v[20:23], v3, s[16:19], s31 offen offset:1024
  v_mfma_f32_32x32x16_bf16 v[192:207], v[76:79], v[68:71], v[192:207]
  ds_read_b64 v[44:45], v218 offset:224
  ds_read_b64 v[46:47], v218 offset:232
  buffer_load_dwordx4 v[112:115], v3, s[16:19], s33 offen
  s_waitcnt lgkmcnt(6)
  v_mfma_f32_32x32x16_bf16 v[176:191], v[80:83], v[84:87], v[176:191]
  ds_read_b64 v[48:49], v218 offset:2240
  ds_read_b64 v[50:51], v218 offset:2248
  buffer_load_dwordx4 v[116:119], v3, s[16:19], s33 offen offset:1024
  v_mfma_f32_32x32x16_bf16 v[192:207], v[80:83], v[88:91], v[192:207]
  ds_read_b128 v[52:55], v219 offset:240
  ds_read_b128 v[56:59], v219 offset:2800
  buffer_load_dwordx4 v[24:27], v3, s[16:19], s30 offen
  v_mfma_f32_32x32x16_bf16 v[192:207], v[92:95], v[84:87], v[192:207]
  ds_read_b64 v[60:61], v218 offset:192
  ds_read_b64 v[62:63], v218 offset:200
  buffer_load_dwordx4 v[28:31], v3, s[16:19], s30 offen offset:1024
  s_waitcnt lgkmcnt(6)
  v_mfma_f32_32x32x16_bf16 v[176:191], v[32:35], v[36:39], v[176:191]
  ds_read_b64 v[64:65], v218 offset:2208
  ds_read_b64 v[66:67], v218 offset:2216
  s_mov_b64 exec, s[46:47]
  buffer_load_dwordx4 v[144:147], v4, s[16:19], s33 offen
  buffer_load_dwordx4 v[148:151], v7, s[16:19], s33 offen
  s_mov_b64 exec, -1
  v_mfma_f32_32x32x16_bf16 v[192:207], v[32:35], v[40:43], v[192:207]
  ds_read_b128 v[68:71], v219 offset:192
  ds_read_b128 v[72:75], v219 offset:2752
  s_add_u32 s33, s33, 28672
  s_cmp_eq_u32 s33, s55
  s_cselect_b32 s33, s54, s33
  v_mfma_f32_32x32x16_bf16 v[192:207], v[44:47], v[36:39], v[192:207]
  ds_read_b64 v[76:77], v218 offset:160
  ds_read_b64 v[78:79], v218 offset:168
  buffer_load_dwordx4 v[120:123], v3, s[16:19], s33 offen
  s_waitcnt lgkmcnt(6)
  v_mfma_f32_32x32x16_bf16 v[176:191], v[48:51], v[52:55], v[176:191]
  ds_read_b64 v[80:81], v218 offset:2176
  ds_read_b64 v[82:83], v218 offset:2184
  buffer_load_dwordx4 v[124:127], v3, s[16:19], s33 offen offset:1024
  v_mfma_f32_32x32x16_bf16 v[192:207], v[48:51], v[56:59], v[192:207]
  ds_read_b128 v[84:87], v219 offset:160
  ds_read_b128 v[88:91], v219 offset:2720
  s_mov_b64 exec, s[46:47]
  buffer_load_dwordx4 v[152:155], v4, s[16:19], s33 offen
  buffer_load_dwordx4 v[156:159], v7, s[16:19], s33 offen
  s_mov_b64 exec, -1
  v_mfma_f32_32x32x16_bf16 v[192:207], v[60:63], v[52:55], v[192:207]
  ds_read_b64 v[92:93], v218 offset:128
  ds_read_b64 v[94:95], v218 offset:136
  s_add_u32 s33, s33, 28672
  s_cmp_eq_u32 s33, s55
  s_cselect_b32 s33, s54, s33
  s_waitcnt lgkmcnt(6)
  v_mfma_f32_32x32x16_bf16 v[176:191], v[64:67], v[68:71], v[176:191]
  ds_read_b64 v[32:33], v218 offset:2144
  ds_read_b64 v[34:35], v218 offset:2152
  buffer_load_dwordx4 v[128:131], v3, s[16:19], s33 offen
  v_mfma_f32_32x32x16_bf16 v[192:207], v[64:67], v[72:75], v[192:207]
  ds_read_b128 v[36:39], v219 offset:112
  ds_read_b128 v[40:43], v219 offset:2672
  buffer_load_dwordx4 v[132:135], v3, s[16:19], s33 offen offset:1024
  v_mfma_f32_32x32x16_bf16 v[192:207], v[76:79], v[68:71], v[192:207]
  ds_read_b64 v[44:45], v218 offset:96
  ds_read_b64 v[46:47], v218 offset:104
  s_mov_b64 exec, s[46:47]
  buffer_load_dwordx4 v[160:163], v4, s[16:19], s33 offen
  buffer_load_dwordx4 v[164:167], v7, s[16:19], s33 offen
  s_mov_b64 exec, -1
  s_waitcnt lgkmcnt(6)
  v_mfma_f32_32x32x16_bf16 v[176:191], v[80:83], v[84:87], v[176:191]
  ds_read_b64 v[48:49], v218 offset:2112
  ds_read_b64 v[50:51], v218 offset:2120
  s_add_u32 s33, s33, 28672
  s_cmp_eq_u32 s33, s55
  s_cselect_b32 s33, s54, s33
  v_mfma_f32_32x32x16_bf16 v[192:207], v[80:83], v[88:91], v[192:207]
  ds_read_b128 v[52:55], v219 offset:80
  ds_read_b128 v[56:59], v219 offset:2640
  buffer_load_dwordx4 v[136:139], v3, s[16:19], s33 offen
  v_mfma_f32_32x32x16_bf16 v[192:207], v[92:95], v[84:87], v[192:207]
  ds_read_b64 v[60:61], v218 offset:64
  ds_read_b64 v[62:63], v218 offset:72
  buffer_load_dwordx4 v[140:143], v3, s[16:19], s33 offen offset:1024
  s_waitcnt lgkmcnt(6)
  v_mfma_f32_32x32x16_bf16 v[176:191], v[32:35], v[36:39], v[176:191]
  ds_read_b64 v[64:65], v218 offset:2080
  ds_read_b64 v[66:67], v218 offset:2088
  v_mfma_f32_32x32x16_bf16 v[192:207], v[32:35], v[40:43], v[192:207]
  ds_read_b128 v[68:71], v219 offset:32
  ds_read_b128 v[72:75], v219 offset:2592
  v_mfma_f32_32x32x16_bf16 v[192:207], v[44:47], v[36:39], v[192:207]
  ds_read_b64 v[76:77], v218 offset:32
  ds_read_b64 v[78:79], v218 offset:40
  s_waitcnt lgkmcnt(6)
  v_mfma_f32_32x32x16_bf16 v[176:191], v[48:51], v[52:55], v[176:191]
  ds_read_b64 v[80:81], v218 offset:2048
  ds_read_b64 v[82:83], v218 offset:2056
  v_mfma_f32_32x32x16_bf16 v[192:207], v[48:51], v[56:59], v[192:207]
  ds_read_b128 v[84:87], v219 offset:0
  ds_read_b128 v[88:91], v219 offset:2560
  v_mfma_f32_32x32x16_bf16 v[192:207], v[60:63], v[52:55], v[192:207]
  ds_read_b64 v[92:93], v218 offset:0
  ds_read_b64 v[94:95], v218 offset:8
  s_waitcnt lgkmcnt(6)
  v_mfma_f32_32x32x16_bf16 v[176:191], v[64:67], v[68:71], v[176:191]
  v_mfma_f32_32x32x16_bf16 v[192:207], v[64:67], v[72:75], v[192:207]
  v_mfma_f32_32x32x16_bf16 v[192:207], v[76:79], v[68:71], v[192:207]
  s_waitcnt lgkmcnt(0)
  v_mfma_f32_32x32x16_bf16 v[176:191], v[80:83], v[84:87], v[176:191]
  v_mfma_f32_32x32x16_bf16 v[192:207], v[80:83], v[88:91], v[192:207]
  v_mfma_f32_32x32x16_bf16 v[192:207], v[92:95], v[84:87], v[192:207]
  s_setprio 1
  s_cmp_eq_u32 s60, 0
  s_nop 8
  s_cbranch_scc1 S_h0
  s_nop 6
  ds_write_b128 v216, v[176:179] offset:0
  ds_write_b128 v216, v[180:183] offset:1024
  ds_write_b128 v216, v[184:187] offset:2048
  ds_write_b128 v216, v[188:191] offset:3072
  s_waitcnt lgkmcnt(0)
  s_mov_b64 exec, 1
  ds_add_u32 v249, v251 offset:0
  s_mov_b64 exec, -1
GW4:
  ds_read_b32 v2, v249 offset:0
  s_waitcnt lgkmcnt(0)
  v_readfirstlane_b32 s62, v2
  s_nop 0
  s_cmp_ge_u32 s62, 4
  s_cbranch_scc1 GW4_ok
  s_sleep 1
  s_add_u32 s95, s95, 1
  s_cmp_lt_u32 s95, 0x2000000
  s_cbranch_scc1 GW4
GW4_ok:
  ds_read_b128 v[64:67], v217 offset:0
  ds_read_b128 v[68:71], v217 offset:1024
  ds_read_b128 v[72:75], v217 offset:2048
  ds_read_b128 v[76:79], v217 offset:3072
  s_waitcnt lgkmcnt(3)
  v_add_f32 v64, v64, v192
  v_add_f32 v65, v65, v193
  v_add_f32 v66, v66, v194
  v_add_f32 v67, v67, v195
  s_waitcnt lgkmcnt(2)
  v_add_f32 v68, v68, v196
  v_add_f32 v69, v69, v197
  v_add_f32 v70, v70, v198
  v_add_f32 v71, v71, v199
  s_waitcnt lgkmcnt(1)
  v_add_f32 v72, v72, v200
  v_add_f32 v73, v73, v201
  v_add_f32 v74, v74, v202
  v_add_f32 v75, v75, v203
  s_waitcnt lgkmcnt(0)
  v_add_f32 v76, v76, v204
  v_add_f32 v77, v77, v205
  v_add_f32 v78, v78, v206
  v_add_f32 v79, v79, v207
  s_branch S_h1
S_h0:
  ds_write_b128 v216, v[192:195] offset:0
  ds_write_b128 v216, v[196:199] offset:1024
  ds_write_b128 v216, v[200:203] offset:2048
  ds_write_b128 v216, v[204:207] offset:3072
  s_waitcnt lgkmcnt(0)
  s_mov_b64 exec, 1
  ds_add_u32 v249, v251 offset:0
  s_mov_b64 exec, -1
GW5:
  ds_read_b32 v2, v249 offset:0
  s_waitcnt lgkmcnt(0)
  v_readfirstlane_b32 s62, v2
  s_nop 0
  s_cmp_ge_u32 s62, 4
  s_cbranch_scc1 GW5_ok
  s_sleep 1
  s_add_u32 s95, s95, 1
  s_cmp_lt_u32 s95, 0x2000000
  s_cbranch_scc1 GW5
GW5_ok:
  ds_read_b128 v[64:67], v217 offset:0
  ds_read_b128 v[68:71], v217 offset:1024
  ds_read_b128 v[72:75], v217 offset:2048
  ds_read_b128 v[76:79], v217 offset:3072
  s_waitcnt lgkmcnt(3)
  v_add_f32 v64, v64, v176
  v_add_f32 v65, v65, v177
  v_add_f32 v66, v66, v178
  v_add_f32 v67, v67, v179
  s_waitcnt lgkmcnt(2)
  v_add_f32 v68, v68, v180
  v_add_f32 v69, v69, v181
  v_add_f32 v70, v70, v182
  v_add_f32 v71, v71, v183
  s_waitcnt lgkmcnt(1)
  v_add_f32 v72, v72, v184
  v_add_f32 v73, v73, v185
  v_add_f32 v74, v74, v186
  v_add_f32 v75, v75, v187
  s_waitcnt lgkmcnt(0)
  v_add_f32 v76, v76, v188
  v_add_f32 v77, v77, v189
  v_add_f32 v78, v78, v190
  v_add_f32 v79, v79, v191
S_h1:
  s_mov_b64 exec, 1
  ds_add_u32 v249, v251 offset:0
  s_mov_b64 exec, -1
  v_cvt_pk_bf16_f32 v176, v64, v65
  v_cvt_pk_bf16_f32 v177, v66, v67
  v_cvt_pk_bf16_f32 v178, v68, v69
  v_cvt_pk_bf16_f32 v179, v70, v71
  v_cvt_pk_bf16_f32 v180, v72, v73
  v_cvt_pk_bf16_f32 v181, v74, v75
  v_cvt_pk_bf16_f32 v182, v76, v77
  v_cvt_pk_bf16_f32 v183, v78, v79
  v_permlane32_swap_b32 v176, v178
  v_permlane32_swap_b32 v177, v179
  v_permlane32_swap_b32 v180, v182
  v_permlane32_swap_b32 v181, v183
  buffer_store_dwordx4 v[176:179], v220, s[16:19], 0 offen sc1
  buffer_store_dwordx4 v[180:183], v220, s[16:19], 0 offen offset:32 sc1
  v_mov_b64 v[32:33], 0
  v_mov_b64 v[34:35], 0
  v_mov_b64 v[36:37], 0
  v_mov_b64 v[38:39], 0
  v_mov_b64 v[40:41], 0
  v_mov_b64 v[42:43], 0
  v_mov_b64 v[44:45], 0
  v_mov_b64 v[46:47], 0
  v_mov_b64 v[48:49], 0
  v_mov_b64 v[50:51], 0
  v_mov_b64 v[52:53], 0
  v_mov_b64 v[54:55], 0
  v_mov_b64 v[56:57], 0
  v_mov_b64 v[58:59], 0
  v_mov_b64 v[60:61], 0
  v_mov_b64 v[62:63], 0
  v_mov_b64 v[104:105], 0
  v_mov_b64 v[106:107], 0
  v_mov_b64 v[108:109], 0
  v_mov_b64 v[110:111], 0
  v_mov_b64 v[92:93], 0
  v_mov_b64 v[94:95], 0
  s_branch L_att
Q_udma:
  s_add_u32 s56, s57, 16
  s_mov_b32 m0, 133632
  s_nop 0
  buffer_load_dwordx4 v220, s[16:19], s57 offen sc1 lds
  s_mov_b32 m0, 134656
  s_nop 0
  buffer_load_dwordx4 v221, s[16:19], s57 offen sc1 lds
  s_mov_b32 m0, 135680
  s_nop 0
  buffer_load_dwordx4 v222, s[16:19], s57 offen sc1 lds
  s_mov_b32 m0, 136704
  s_nop 0
  buffer_load_dwordx4 v252, s[16:19], s57 offen sc1 lds
  s_mov_b32 m0, 137728
  s_nop 0
  buffer_load_dwordx4 v255, s[16:19], s57 offen sc1 lds
  s_mov_b32 m0, 141312
  s_nop 0
  buffer_load_dwordx4 v220, s[16:19], s56 offen sc1 lds
  s_mov_b32 m0, 142336
  s_nop 0
  buffer_load_dwordx4 v221, s[16:19], s56 offen sc1 lds
  s_mov_b32 m0, 143360
  s_nop 0
  buffer_load_dwordx4 v222, s[16:19], s56 offen sc1 lds
  s_mov_b32 m0, 144384
  s_nop 0
  buffer_load_dwordx4 v252, s[16:19], s56 offen sc1 lds
  s_mov_b32 m0, 145408
  s_nop 0
  buffer_load_dwordx4 v255, s[16:19], s56 offen sc1 lds
  s_mov_b32 s60, 0
  s_setpc_b64 s[90:91]
L_lite:
  s_waitcnt lgkmcnt(0)
  s_mov_b32 s4, s66
  s_and_b32 s5, s67, 0xffff
  s_mov_b32 s6, 1204224
  s_mov_b32 s7, 0x20000
  s_sub_u32 s36, s23, 28
  s_lshl_b32 s36, s36, 3
  s_add_u32 s36, s36, s3
  s_mul_i32 s36, s36, 37632
  v_lshrrev_b32 v2, 3, v1
  v_min_u32 v4, 5, v2
  v_mul_u32_u24 v2, 2688, v2
  v_mul_u32_u24 v4, 2688, v4
  v_and_b32 v3, 7, v1
  v_lshl_add_u32 v2, v3, 4, v2
  v_lshl_add_u32 v4, v3, 4, v4
  s_add_u32 s37, s36, 384
  buffer_load_dwordx4 v[64:67], v2, s[4:7], s37 offen
  s_add_u32 s37, s37, 21504
  buffer_load_dwordx4 v[68:71], v4, s[4:7], s37 offen
  v_lshrrev_b32 v2, 5, v1
  v_mul_u32_u24 v2, 2688, v2
  v_and_b32 v3, 31, v1
  v_lshl_add_u32 v2, v3, 4, v2
  s_mul_i32 s37, s27, 384
  s_add_u32 s36, s36, s37
  s_add_u32 s37, s36, 896
  buffer_load_dwordx4 v[72:75], v2, s[4:7], s37 offen
  s_add_u32 s37, s36, 6272
  buffer_load_dwordx4 v[76:79], v2, s[4:7], s37 offen
  s_add_u32 s37, s36, 11648
  buffer_load_dwordx4 v[80:83], v2, s[4:7], s37 offen
  s_add_u32 s37, s36, 17024
  buffer_load_dwordx4 v[84:87], v2, s[4:7], s37 offen
  s_add_u32 s37, s36, 22400
  buffer_load_dwordx4 v[88:91], v2, s[4:7], s37 offen
  s_add_u32 s37, s36, 27776
  buffer_load_dwordx4 v[92:95], v2, s[4:7], s37 offen
  s_add_u32 s37, s36, 33152
  buffer_load_dwordx4 v[96:99], v2, s[4:7], s37 offen
  s_add_u32 s37, s36, 1792
  buffer_load_dwordx4 v[100:103], v2, s[4:7], s37 offen
  s_add_u32 s37, s36, 7168
  buffer_load_dwordx4 v[104:107], v2, s[4:7], s37 offen
  s_add_u32 s37, s36, 12544
  buffer_load_dwordx4 v[108:111], v2, s[4:7], s37 offen
  s_add_u32 s37, s36, 17920
  buffer_load_dwordx4 v[112:115], v2, s[4:7], s37 offen
  s_add_u32 s37, s36, 23296
  buffer_load_dwordx4 v[116:119], v2, s[4:7], s37 offen
  s_add_u32 s37, s36, 28672
  buffer_load_dwordx4 v[120:123], v2, s[4:7], s37 offen
  s_add_u32 s37, s36, 34048
  buffer_load_dwordx4 v[124:127], v2, s[4:7], s37 offen
  s_mov_b32 s16, s88
  s_and_b32 s17, s89, 0xffff
  s_mov_b32 s18, 11403264
  s_mov_b32 s19, 0x20000
  s_mov_b32 s12, s84
  s_and_b32 s13, s85, 0xffff
  s_mov_b32 s14, 3670016
  s_mov_b32 s15, 0x20000
  s_mov_b32 s36, 98304
  buffer_load_dword v253, off, s[16:19], s36 sc1
  s_waitcnt vmcnt(0)
  v_readfirstlane_b32 s20, v253
  s_nop 0
  s_add_u32 s20, s20, 1
  s_mov_b32 s95, 0
  s_lshl_b32 s40, s22, 1
  s_and_b32 s41, s23, 1
  s_add_u32 s40, s40, s41
  s_lshr_b32 s41, s23, 1
  s_mov_b32 s99, s41
  s_mul_i32 s42, s40, 7
  s_lshr_b32 s42, s42, 1
  s_lshr_b32 s43, s42, 3
  s_add_u32 s44, s42, 3
  s_lshr_b32 s44, s44, 3
  s_lshl_b32 s43, s43, 9
  s_lshl_b32 s44, s44, 9
  v_mov_b32 v176, s43
  v_mov_b32 v177, s44
  v_cmp_lt_u32 vcc, 31, v1
  s_nop 1
  v_cndmask_b32 v176, v176, v177, vcc
  v_and_b32 v177, 31, v1
  v_lshl_add_u32 v176, v177, 4, v176
  v_add_u32 v176, 32768, v176
  s_lshl_b32 s40, s22, 1
  s_and_b32 s41, s23, 1
  s_add_u32 s40, s40, s41
  s_lshr_b32 s41, s23, 1
  s_mov_b32 s99, s41
  s_mul_i32 s42, s40, 7
  s_lshr_b32 s42, s42, 1
  s_and_b32 s24, s3, 1
  s_lshr_b32 s27, s3, 1
  s_cmp_lt_u32 s23, 28
  s_cselect_b32 s34, 16, 16
  s_sub_u32 s35, 32, s34
  s_min_u32 s54, s27, 2
  s_mul_i32 s54, s54, s34
  s_cmp_eq_u32 s27, 3
  s_cselect_b32 s55, s35, 0
  s_add_u32 s54, s54, s55
  s_cmp_lt_u32 s3, 4
  s_cselect_b32 s34, s34, s35
  s_lshr_b32 s35, s34, 2
  s_lshl_b32 s96, s42, 9
  v_lshl_add_u32 v3, v1, 4, s96
  s_lshl_b32 s28, s41, 2
  s_lshl_b32 s31, s24, 1
  s_add_u32 s28, s28, s31
  s_mul_i32 s31, s28, 28672
  s_add_u32 s31, s31, 131072
  s_add_u32 s30, s31, 28672
  s_mul_i32 s54, s54, 28672
  s_add_u32 s54, s54, 1966080
  s_mul_i32 s55, s34, 28672
  s_add_u32 s55, s55, s54
  s_mul_i32 s33, s99, s34
  s_lshr_b32 s33, s33, 4
  s_mul_i32 s33, s33, 28672
  s_add_u32 s33, s33, s54
  v_and_b32 v5, 31, v1
  v_lshrrev_b32 v6, 5, v1
  v_mul_u32_u24 v4, 7168, v6
  v_lshl_add_u32 v4, v5, 4, v4
  s_mul_i32 s97, s40, 448
  s_add_u32 s97, s97, 1835008
  v_add_u32 v4, s97, v4
  v_add_u32 v7, 14336, v4
  s_mov_b32 s46, 0x0fffffff
  s_mov_b32 s47, 0x0fffffff
  v_cmp_eq_u32 vcc, 28, v5
  v_mov_b32 v12, 0x3f803f80
  s_nop 0
  v_cndmask_b32 v12, 0, v12, vcc
  v_mov_b32 v13, v12
  v_mov_b64 v[144:145], v[12:13]
  v_mov_b64 v[146:147], v[12:13]
  v_mov_b64 v[148:149], v[12:13]
  v_mov_b64 v[150:151], v[12:13]
  v_mov_b64 v[152:153], v[12:13]
  v_mov_b64 v[154:155], v[12:13]
  v_mov_b64 v[156:157], v[12:13]
  v_mov_b64 v[158:159], v[12:13]
  v_mov_b64 v[160:161], v[12:13]
  v_mov_b64 v[162:163], v[12:13]
  v_mov_b64 v[164:165], v[12:13]
  v_mov_b64 v[166:167], v[12:13]
  v_mov_b64 v[168:169], v[12:13]
  v_mov_b64 v[170:171], v[12:13]
  v_mov_b64 v[172:173], v[12:13]
  v_mov_b64 v[174:175], v[12:13]
  s_mov_b32 s8, s68
  s_and_b32 s9, s69, 0xffff
  s_mov_b32 s10, 401408
  s_mov_b32 s11, 0x20000
  s_lshr_b32 s52, s40, 2
  s_lshl_b32 s53, s41, 2
  s_add_u32 s52, s52, s53
  s_and_b32 s53, s40, 3
  v_lshrrev_b32 v8, 4, v1
  v_and_b32 v9, 15, v1
  v_lshlrev_b32 v10, 2, v8
  v_xor_b32 v9, v9, v10
  v_lshlrev_b32 v9, 4, v9
  v_mul_u32_u24 v8, 896, v8
  v_add_u32 v8, v8, v9
  s_lshl_b32 s98, s53, 8
  v_add_u32 v8, s98, v8
  s_lshl_b32 s51, s3, 10
  s_mul_i32 s50, s3, 3584
  s_sub_u32 s35, s35, 1
  s_and_b32 s49, s40, 1
  s_cmp_eq_u32 s49, 0
  s_cselect_b32 s43, -1, 0
  s_mov_b32 s42, 0
  s_cselect_b32 s44, 0, -1
  s_mov_b32 s45, 0
  s_lshl_b32 s32, s21, 4
  s_and_b32 s49, s3, 3
  s_lshl_b32 s49, s49, 2
  s_add_u32 s32, s32, s49
  s_add_u32 s32, s32, 102400
  s_cmp_lt_u32 s23, 28
  s_cselect_b32 s32, s32, 11403264
  s_lshl_b32 s36, s24, 14
  s_add_u32 s36, s36, 98304
  s_lshr_b32 s5, s27, 1
  s_lshl_b32 s5, s5, 15
  s_and_b32 s49, s27, 1
  s_lshl_b32 s49, s49, 11
  s_add_u32 s5, s5, s49
  s_add_u32 s5, s5, s36
  v_lshl_add_u32 v240, v1, 4, s5
  s_lshl_b32 s6, s27, 12
  s_add_u32 s6, s6, s36
  v_lshl_add_u32 v241, v1, 4, s6
  s_or_b32 s7, s27, 1
  s_lshl_b32 s7, s7, 12
  s_add_u32 s7, s7, s36
  s_add_u32 s7, s7, 1536
  v_lshl_add_u32 v242, v5, 4, s7
  v_lshlrev_b32 v243, 13, v6
  v_lshl_add_u32 v243, v5, 4, v243
  v_add_u32 v243, 103936, v243
  s_and_b32 s36, s27, 1
  s_cmp_eq_u32 s36, 1
  s_cselect_b32 s101, -1, 0
  s_mov_b32 s100, 0
  s_lshr_b32 s4, s27, 1
  s_add_u32 s4, s4, s28
  s_lshl_b32 s4, s4, 15
  s_lshl_b32 s49, s40, 11
  s_add_u32 s4, s4, s49
  s_lshl_b32 s49, s36, 10
  s_add_u32 s4, s4, s49
  s_add_u32 s4, s4, 5636096
  s_lshl_b32 s92, s25, 9
  s_add_u32 s92, s92, 102400
  v_lshl_add_u32 v238, v5, 4, s92
  v_lshlrev_b32 v239, 12, v1
  s_lshl_b32 s93, s25, 18
  s_lshl_b32 s36, s26, 7
  s_add_u32 s93, s93, s36
  s_and_b32 s36, s3, 3
  s_lshl_b32 s36, s36, 5
  s_add_u32 s93, s93, s36
  s_add_u32 s93, s93, 9568256
  v_mov_b64 v[32:33], 0
  v_mov_b64 v[34:35], 0
  v_mov_b64 v[36:37], 0
  v_mov_b64 v[38:39], 0
  v_mov_b64 v[40:41], 0
  v_mov_b64 v[42:43], 0
  v_mov_b64 v[44:45], 0
  v_mov_b64 v[46:47], 0
  v_mov_b64 v[48:49], 0
  v_mov_b64 v[50:51], 0
  v_mov_b64 v[52:53], 0
  v_mov_b64 v[54:55], 0
  v_mov_b64 v[56:57], 0
  v_mov_b64 v[58:59], 0
  v_mov_b64 v[60:61], 0
  v_mov_b64 v[62:63], 0
  v_mov_b64 v[104:105], 0
  v_mov_b64 v[106:107], 0
  v_mov_b64 v[108:109], 0
  v_mov_b64 v[110:111], 0
  v_mov_b64 v[92:93], 0
  v_mov_b64 v[94:95], 0
  s_sub_u32 s36, s23, 28
  s_lshl_b32 s36, s36, 3
  s_add_u32 s36, s36, s3
  s_mul_i32 s36, s36, 12544
  v_lshl_add_u32 v2, v1, 4, s36
  s_mov_b32 s36, 0
  buffer_load_dwordx4 v[184:187], v2, s[8:11], s36 offen
  s_mov_b32 s36, 1024
  buffer_load_dwordx4 v[188:191], v2, s[8:11], s36 offen
  s_mov_b32 s36, 2048
  buffer_load_dwordx4 v[192:195], v2, s[8:11], s36 offen
  s_mov_b32 s36, 3072
  buffer_load_dwordx4 v[196:199], v2, s[8:11], s36 offen
  s_mov_b32 s36, 4096
  buffer_load_dwordx4 v[200:203], v2, s[8:11], s36 offen
  s_mov_b32 s36, 5120
  buffer_load_dwordx4 v[204:207], v2, s[8:11], s36 offen
  s_mov_b32 s36, 6144
  buffer_load_dwordx4 v[208:211], v2, s[8:11], s36 offen
  s_mov_b32 s36, 7168
  buffer_load_dwordx4 v[212:215], v2, s[8:11], s36 offen
  s_mov_b32 s36, 8192
  buffer_load_dwordx4 v[216:219], v2, s[8:11], s36 offen
  s_mov_b32 s36, 9216
  buffer_load_dwordx4 v[220:223], v2, s[8:11], s36 offen
  s_mov_b32 s36, 10240
  buffer_load_dwordx4 v[224:227], v2, s[8:11], s36 offen
  s_mov_b32 s36, 11264
  buffer_load_dwordx4 v[228:231], v2, s[8:11], s36 offen
  s_mov_b32 s36, 12288
  buffer_load_dwordx4 v[232:235], v2, s[8:11], s36 offen
  s_waitcnt vmcnt(0)
  s_cmp_lg_u32 s3, 0
  s_cbranch_scc1 L_lite1
  s_mov_b32 exec_lo, 0
  s_mov_b32 exec_hi, 2147483648
  s_mov_b32 s62, 0
PL_f1a:
  buffer_load_dwordx4 v[180:183], v176, s[16:19], 0 offen sc1
  s_waitcnt vmcnt(0)
  v_xor_b32 v180, s20, v180
  v_xor_b32 v181, s20, v181
  v_xor_b32 v182, s20, v182
  v_xor_b32 v183, s20, v183
  v_or3_b32 v180, v180, v181, v182
  v_or_b32 v180, v180, v183
  v_cmp_ne_u32 vcc, 0, v180
  s_nop 4
  s_cbranch_vccz PL_f1a_ok
  s_sleep 4
  s_add_u32 s62, s62, 1
  s_cmp_lt_u32 s62, 1000000
  s_cbranch_scc1 PL_f1a
PL_f1a_ok:
  s_mov_b64 exec, -1
  s_mov_b32 s62, 0
PL_f1b:
  buffer_load_dwordx4 v[180:183], v176, s[16:19], 0 offen sc1
  s_waitcnt vmcnt(0)
  v_xor_b32 v180, s20, v180
  v_xor_b32 v181, s20, v181
  v_xor_b32 v182, s20, v182
  v_xor_b32 v183, s20, v183
  v_or3_b32 v180, v180, v181, v182
  v_or_b32 v180, v180, v183
  v_cmp_ne_u32 vcc, 0, v180
  s_nop 4
  s_cbranch_vccz PL_f1b_ok
  s_sleep 1
  s_add_u32 s62, s62, 1
  s_cmp_lt_u32 s62, 1000000
  s_cbranch_scc1 PL_f1b
PL_f1b_ok:
  s_mov_b64 exec, -1
L_lite1:
  s_setprio 2
  s_barrier
  s_branch L_pre
L_att:
  s_waitcnt vmcnt(12)
  s_mov_b64 exec, s[42:43]
  v_mov_b32 v22, 0
  v_mov_b32 v23, 0
  v_mov_b32 v30, 0
  v_mov_b32 v31, 0
  s_mov_b64 exec, s[44:45]
  v_mov_b32 v16, 0
  v_mov_b32 v17, 0
  v_mov_b32 v24, 0
  v_mov_b32 v25, 0
  s_mov_b64 exec, -1
  v_mfma_f32_32x32x16_bf16 v[64:79], v[112:115], v[16:19], 0
  v_mfma_f32_32x32x16_bf16 v[64:79], v[116:119], v[20:23], v[64:79]
  s_nop 9
L_att2:
  v_lshlrev_b32 v2, 4, v1
  s_mov_b32 s37, 0
  s_cmp_lt_u32 s3, 4
  s_cbranch_scc1 A_noprio
  s_setprio 1
A_noprio:
.p2align 6
A_loop:
  v_mfma_f32_32x32x16_bf16 v[48:63], v[168:171], v[104:107], v[48:63]
  v_exp_f32 v64, v64
  v_cvt_pk_bf16_f32 v110, v92, v93
  v_exp_f32 v65, v65
  v_exp_f32 v66, v66
  v_cvt_pk_bf16_f32 v111, v94, v95
  v_exp_f32 v67, v67
  v_mfma_f32_32x32x16_bf16 v[80:95], v[112:115], v[24:27], 0
  v_exp_f32 v68, v68
  v_cvt_pk_bf16_f32 v96, v64, v65
  v_exp_f32 v69, v69
  v_exp_f32 v70, v70
  v_cvt_pk_bf16_f32 v97, v66, v67
  v_exp_f32 v71, v71
  v_mfma_f32_32x32x16_bf16 v[80:95], v[116:119], v[28:31], v[80:95]
  v_exp_f32 v72, v72
  v_cvt_pk_bf16_f32 v98, v68, v69
  v_exp_f32 v73, v73
  v_exp_f32 v74, v74
  v_cvt_pk_bf16_f32 v99, v70, v71
  v_exp_f32 v75, v75
  v_mfma_f32_32x32x16_bf16 v[48:63], v[172:175], v[108:111], v[48:63]
  v_exp_f32 v76, v76
  v_cvt_pk_bf16_f32 v100, v72, v73
  v_exp_f32 v77, v77
  v_exp_f32 v78, v78
  v_cvt_pk_bf16_f32 v101, v74, v75
  v_exp_f32 v79, v79
  s_waitcnt vmcnt(8)
  v_mfma_f32_32x32x16_bf16 v[32:47], v[144:147], v[96:99], v[32:47]
  v_exp_f32 v80, v80
  v_cvt_pk_bf16_f32 v102, v76, v77
  v_exp_f32 v81, v81
  s_mov_b64 exec, s[46:47]
  buffer_load_dwordx4 v[168:171], v4, s[16:19], s33 offen
  buffer_load_dwordx4 v[172:175], v7, s[16:19], s33 offen
  s_mov_b64 exec, -1
  v_exp_f32 v82, v82
  v_cvt_pk_bf16_f32 v103, v78, v79
  v_exp_f32 v83, v83
  v_mfma_f32_32x32x16_bf16 v[64:79], v[120:123], v[16:19], 0
  v_exp_f32 v84, v84
  v_cvt_pk_bf16_f32 v104, v80, v81
  v_exp_f32 v85, v85
  s_add_u32 s33, s33, 28672
  s_cmp_eq_u32 s33, s55
  s_cselect_b32 s33, s54, s33
  v_exp_f32 v86, v86
  v_cvt_pk_bf16_f32 v105, v82, v83
  v_exp_f32 v87, v87
  v_mfma_f32_32x32x16_bf16 v[64:79], v[124:127], v[20:23], v[64:79]
  v_exp_f32 v88, v88
  v_cvt_pk_bf16_f32 v106, v84, v85
  v_exp_f32 v89, v89
  buffer_load_dwordx4 v[112:115], v3, s[16:19], s33 offen
  v_exp_f32 v90, v90
  v_cvt_pk_bf16_f32 v107, v86, v87
  v_exp_f32 v91, v91
  v_mfma_f32_32x32x16_bf16 v[32:47], v[148:151], v[100:103], v[32:47]
  v_exp_f32 v92, v92
  v_cvt_pk_bf16_f32 v108, v88, v89
  v_exp_f32 v93, v93
  buffer_load_dwordx4 v[116:119], v3, s[16:19], s33 offen offset:1024
  v_exp_f32 v94, v94
  v_cvt_pk_bf16_f32 v109, v90, v91
  v_exp_f32 v95, v95
  v_mfma_f32_32x32x16_bf16 v[48:63], v[144:147], v[104:107], v[48:63]
  v_exp_f32 v64, v64
  v_cvt_pk_bf16_f32 v110, v92, v93
  v_exp_f32 v65, v65
  v_exp_f32 v66, v66
  v_cvt_pk_bf16_f32 v111, v94, v95
  v_exp_f32 v67, v67
  v_mfma_f32_32x32x16_bf16 v[80:95], v[120:123], v[24:27], 0
  v_exp_f32 v68, v68
  v_cvt_pk_bf16_f32 v96, v64, v65
  v_exp_f32 v69, v69
  v_exp_f32 v70, v70
  v_cvt_pk_bf16_f32 v97, v66, v67
  v_exp_f32 v71, v71
  v_mfma_f32_32x32x16_bf16 v[80:95], v[124:127], v[28:31], v[80:95]
  v_exp_f32 v72, v72
  v_cvt_pk_bf16_f32 v98, v68, v69
  v_exp_f32 v73, v73
  v_exp_f32 v74, v74
  v_cvt_pk_bf16_f32 v99, v70, v71
  v_exp_f32 v75, v75
  v_mfma_f32_32x32x16_bf16 v[48:63], v[148:151], v[108:111], v[48:63]
  v_exp_f32 v76, v76
  v_cvt_pk_bf16_f32 v100, v72, v73
  v_exp_f32 v77, v77
  v_exp_f32 v78, v78
  v_cvt_pk_bf16_f32 v101, v74, v75
  v_exp_f32 v79, v79
  s_waitcnt vmcnt(8)
  v_mfma_f32_32x32x16_bf16 v[32:47], v[152:155], v[96:99], v[32:47]
  v_exp_f32 v80, v80
  v_cvt_pk_bf16_f32 v102, v76, v77
  v_exp_f32 v81, v81
  s_mov_b64 exec, s[46:47]
  buffer_load_dwordx4 v[144:147], v4, s[16:19], s33 offen
  buffer_load_dwordx4 v[148:151], v7, s[16:19], s33 offen
  s_mov_b64 exec, -1
  v_exp_f32 v82, v82
  v_cvt_pk_bf16_f32 v103, v78, v79
  v_exp_f32 v83, v83
  v_mfma_f32_32x32x16_bf16 v[64:79], v[128:131], v[16:19], 0
  v_exp_f32 v84, v84
  v_cvt_pk_bf16_f32 v104, v80, v81
  v_exp_f32 v85, v85
  s_add_u32 s33, s33, 28672
  s_cmp_eq_u32 s33, s55
  s_cselect_b32 s33, s54, s33
  v_exp_f32 v86, v86
  v_cvt_pk_bf16_f32 v105, v82, v83
  v_exp_f32 v87, v87
  v_mfma_f32_32x32x16_bf16 v[64:79], v[132:135], v[20:23], v[64:79]
  v_exp_f32 v88, v88
  v_cvt_pk_bf16_f32 v106, v84, v85
  v_exp_f32 v89, v89
  buffer_load_dwordx4 v[120:123], v3, s[16:19], s33 offen
  v_exp_f32 v90, v90
  v_cvt_pk_bf16_f32 v107, v86, v87
  v_exp_f32 v91, v91
  v_mfma_f32_32x32x16_bf16 v[32:47], v[156:159], v[100:103], v[32:47]
  v_exp_f32 v92, v92
  v_cvt_pk_bf16_f32 v108, v88, v89
  v_exp_f32 v93, v93
  buffer_load_dwordx4 v[124:127], v3, s[16:19], s33 offen offset:1024
  v_exp_f32 v94, v94
  v_cvt_pk_bf16_f32 v109, v90, v91
  v_exp_f32 v95, v95
  v_mfma_f32_32x32x16_bf16 v[48:63], v[152:155], v[104:107], v[48:63]
  v_exp_f32 v64, v64
  v_cvt_pk_bf16_f32 v110, v92, v93
  v_exp_f32 v65, v65
  v_exp_f32 v66, v66
  v_cvt_pk_bf16_f32 v111, v94, v95
  v_exp_f32 v67, v67
  v_mfma_f32_32x32x16_bf16 v[80:95], v[128:131], v[24:27], 0
  v_exp_f32 v68, v68
  v_cvt_pk_bf16_f32 v96, v64, v65
  v_exp_f32 v69, v69
  v_exp_f32 v70, v70
  v_cvt_pk_bf16_f32 v97, v66, v67
  v_exp_f32 v71, v71
  v_mfma_f32_32x32x16_bf16 v[80:95], v[132:135], v[28:31], v[80:95]
  v_exp_f32 v72, v72
  v_cvt_pk_bf16_f32 v98, v68, v69
  v_exp_f32 v73, v73
  v_exp_f32 v74, v74
  v_cvt_pk_bf16_f32 v99, v70, v71
  v_exp_f32 v75, v75
  v_mfma_f32_32x32x16_bf16 v[48:63], v[156:159], v[108:111], v[48:63]
  v_exp_f32 v76, v76
  v_cvt_pk_bf16_f32 v100, v72, v73
  v_exp_f32 v77, v77
  v_exp_f32 v78, v78
  v_cvt_pk_bf16_f32 v101, v74, v75
  v_exp_f32 v79, v79
  s_waitcnt vmcnt(8)
  v_mfma_f32_32x32x16_bf16 v[32:47], v[160:163], v[96:99], v[32:47]
  v_exp_f32 v80, v80
  v_cvt_pk_bf16_f32 v102, v76, v77
  v_exp_f32 v81, v81
  s_mov_b64 exec, s[46:47]
  buffer_load_dwordx4 v[152:155], v4, s[16:19], s33 offen
  buffer_load_dwordx4 v[156:159], v7, s[16:19], s33 offen
  s_mov_b64 exec, -1
  v_exp_f32 v82, v82
  v_cvt_pk_bf16_f32 v103, v78, v79
  v_exp_f32 v83, v83
  v_mfma_f32_32x32x16_bf16 v[64:79], v[136:139], v[16:19], 0
  v_exp_f32 v84, v84
  v_cvt_pk_bf16_f32 v104, v80, v81
  v_exp_f32 v85, v85
  s_add_u32 s33, s33, 28672
  s_cmp_eq_u32 s33, s55
  s_cselect_b32 s33, s54, s33
  v_exp_f32 v86, v86
  v_cvt_pk_bf16_f32 v105, v82, v83
  v_exp_f32 v87, v87
  v_mfma_f32_32x32x16_bf16 v[64:79], v[140:143], v[20:23], v[64:79]
  v_exp_f32 v88, v88
  v_cvt_pk_bf16_f32 v106, v84, v85
  v_exp_f32 v89, v89
  buffer_load_dwordx4 v[128:131], v3, s[16:19], s33 offen
  v_exp_f32 v90, v90
  v_cvt_pk_bf16_f32 v107, v86, v87
  v_exp_f32 v91, v91
  v_mfma_f32_32x32x16_bf16 v[32:47], v[164:167], v[100:103], v[32:47]
  v_exp_f32 v92, v92
  v_cvt_pk_bf16_f32 v108, v88, v89
  v_exp_f32 v93, v93
  buffer_load_dwordx4 v[132:135], v3, s[16:19], s33 offen offset:1024
  v_exp_f32 v94, v94
  v_cvt_pk_bf16_f32 v109, v90, v91
  v_exp_f32 v95, v95
  v_mfma_f32_32x32x16_bf16 v[48:63], v[160:163], v[104:107], v[48:63]
  v_exp_f32 v64, v64
  v_cvt_pk_bf16_f32 v110, v92, v93
  v_exp_f32 v65, v65
  v_exp_f32 v66, v66
  v_cvt_pk_bf16_f32 v111, v94, v95
  v_exp_f32 v67, v67
  v_mfma_f32_32x32x16_bf16 v[80:95], v[136:139], v[24:27], 0
  v_exp_f32 v68, v68
  v_cvt_pk_bf16_f32 v96, v64, v65
  v_exp_f32 v69, v69
  v_exp_f32 v70, v70
  v_cvt_pk_bf16_f32 v97, v66, v67
  v_exp_f32 v71, v71
  v_mfma_f32_32x32x16_bf16 v[80:95], v[140:143], v[28:31], v[80:95]
  v_exp_f32 v72, v72
  v_cvt_pk_bf16_f32 v98, v68, v69
  v_exp_f32 v73, v73
  v_exp_f32 v74, v74
  v_cvt_pk_bf16_f32 v99, v70, v71
  v_exp_f32 v75, v75
  v_mfma_f32_32x32x16_bf16 v[48:63], v[164:167], v[108:111], v[48:63]
  v_exp_f32 v76, v76
  v_cvt_pk_bf16_f32 v100, v72, v73
  v_exp_f32 v77, v77
  v_exp_f32 v78, v78
  v_cvt_pk_bf16_f32 v101, v74, v75
  v_exp_f32 v79, v79
  s_waitcnt vmcnt(8)
  v_mfma_f32_32x32x16_bf16 v[32:47], v[168:171], v[96:99], v[32:47]
  v_exp_f32 v80, v80
  v_cvt_pk_bf16_f32 v102, v76, v77
  v_exp_f32 v81, v81
  s_mov_b64 exec, s[46:47]
  buffer_load_dwordx4 v[160:163], v4, s[16:19], s33 offen
  buffer_load_dwordx4 v[164:167], v7, s[16:19], s33 offen
  s_mov_b64 exec, -1
  v_exp_f32 v82, v82
  v_cvt_pk_bf16_f32 v103, v78, v79
  v_exp_f32 v83, v83
  v_mfma_f32_32x32x16_bf16 v[64:79], v[112:115], v[16:19], 0
  v_exp_f32 v84, v84
  v_cvt_pk_bf16_f32 v104, v80, v81
  v_exp_f32 v85, v85
  s_add_u32 s33, s33, 28672
  s_cmp_eq_u32 s33, s55
  s_cselect_b32 s33, s54, s33
  v_exp_f32 v86, v86
  v_cvt_pk_bf16_f32 v105, v82, v83
  v_exp_f32 v87, v87
  v_mfma_f32_32x32x16_bf16 v[64:79], v[116:119], v[20:23], v[64:79]
  v_exp_f32 v88, v88
  v_cvt_pk_bf16_f32 v106, v84, v85
  v_exp_f32 v89, v89
  buffer_load_dwordx4 v[136:139], v3, s[16:19], s33 offen
  v_exp_f32 v90, v90
  v_cvt_pk_bf16_f32 v107, v86, v87
  v_exp_f32 v91, v91
  v_mfma_f32_32x32x16_bf16 v[32:47], v[172:175], v[100:103], v[32:47]
  v_exp_f32 v92, v92
  v_cvt_pk_bf16_f32 v108, v88, v89
  v_exp_f32 v93, v93
  buffer_load_dwordx4 v[140:143], v3, s[16:19], s33 offen offset:1024
  v_exp_f32 v94, v94
  v_cvt_pk_bf16_f32 v109, v90, v91
  v_exp_f32 v95, v95
  s_add_u32 s37, s37, 1
  s_cmp_eq_u32 s37, s35
  s_cbranch_scc1 A_last
  s_cmp_lg_u32 s37, 1
  s_cbranch_scc1 A_loop
  s_cmp_lt_u32 s3, 4
  s_cbranch_scc1 A_loop
  v_mov_b32 v9, s32
  v_mov_b32 v10, s20
  s_mov_b64 exec, 1
  buffer_store_dword v10, v9, s[16:19], 0 offen sc1
  s_mov_b64 exec, -1
  s_branch A_loop
A_last:
  s_cmp_lg_u32 s32, 11403264
  s_cbranch_scc1 A_l0
  s_setprio 0
  s_branch A_l2
A_l0:
  s_cmp_lt_u32 s3, 4
  s_cbranch_scc1 A_l1
  buffer_load_dwordx4 v[196:199], v238, s[16:19], 0 offen sc1
A_l1:
GW6:
  ds_read_b32 v9, v249 offset:0
  s_waitcnt lgkmcnt(0)
  v_readfirstlane_b32 s62, v9
  s_nop 0
  s_cmp_ge_u32 s62, 8
  s_cbranch_scc1 GW6_ok
  s_sleep 1
  s_add_u32 s95, s95, 1
  s_cmp_lt_u32 s95, 0x2000000
  s_cbranch_scc1 GW6
GW6_ok:
A_l2:
  s_waitcnt vmcnt(8)
  v_mfma_f32_32x32x16_bf16 v[48:63], v[168:171], v[104:107], v[48:63]
  v_exp_f32 v64, v64
  v_cvt_pk_bf16_f32 v110, v92, v93
  v_exp_f32 v65, v65
  v_exp_f32 v66, v66
  v_cvt_pk_bf16_f32 v111, v94, v95
  v_exp_f32 v67, v67
  v_mfma_f32_32x32x16_bf16 v[80:95], v[120:123], v[16:19], 0
  v_exp_f32 v68, v68
  v_cvt_pk_bf16_f32 v96, v64, v65
  v_exp_f32 v69, v69
  v_exp_f32 v70, v70
  v_cvt_pk_bf16_f32 v97, v66, v67
  v_exp_f32 v71, v71
  v_mfma_f32_32x32x16_bf16 v[80:95], v[124:127], v[20:23], v[80:95]
  v_exp_f32 v72, v72
  v_cvt_pk_bf16_f32 v98, v68, v69
  v_exp_f32 v73, v73
  v_exp_f32 v74, v74
  v_cvt_pk_bf16_f32 v99, v70, v71
  v_exp_f32 v75, v75
  v_mfma_f32_32x32x16_bf16 v[48:63], v[172:175], v[108:111], v[48:63]
  v_exp_f32 v76, v76
  v_cvt_pk_bf16_f32 v100, v72, v73
  v_exp_f32 v77, v77
  v_exp_f32 v78, v78
  v_cvt_pk_bf16_f32 v101, v74, v75
  v_exp_f32 v79, v79
  s_waitcnt vmcnt(4)
  v_mfma_f32_32x32x16_bf16 v[32:47], v[144:147], v[96:99], v[32:47]
  v_exp_f32 v80, v80
  v_cvt_pk_bf16_f32 v102, v76, v77
  v_exp_f32 v81, v81
  s_mov_b64 exec, s[46:47]
  buffer_load_dwordx4 v[168:171], v4, s[16:19], s33 offen
  buffer_load_dwordx4 v[172:175], v7, s[16:19], s33 offen
  s_mov_b64 exec, -1
  v_exp_f32 v82, v82
  v_cvt_pk_bf16_f32 v103, v78, v79
  v_exp_f32 v83, v83
  v_mfma_f32_32x32x16_bf16 v[64:79], v[128:131], v[16:19], 0
  v_exp_f32 v84, v84
  v_cvt_pk_bf16_f32 v104, v80, v81
  v_exp_f32 v85, v85
  s_add_u32 m0, s51, 0
  s_add_u32 s48, s50, 0
  buffer_load_dwordx4 v8, s[8:11], s48 offen lds
  v_exp_f32 v86, v86
  v_cvt_pk_bf16_f32 v105, v82, v83
  v_exp_f32 v87, v87
  v_mfma_f32_32x32x16_bf16 v[64:79], v[132:135], v[20:23], v[64:79]
  v_exp_f32 v88, v88
  v_cvt_pk_bf16_f32 v106, v84, v85
  v_exp_f32 v89, v89
  s_add_u32 m0, s51, 8192
  s_add_u32 s48, s50, 28672
  buffer_load_dwordx4 v8, s[8:11], s48 offen lds
  v_exp_f32 v90, v90
  v_cvt_pk_bf16_f32 v107, v86, v87
  v_exp_f32 v91, v91
  v_mfma_f32_32x32x16_bf16 v[32:47], v[148:151], v[100:103], v[32:47]
  v_exp_f32 v92, v92
  v_cvt_pk_bf16_f32 v108, v88, v89
  v_exp_f32 v93, v93
  s_add_u32 m0, s51, 16384
  s_add_u32 s48, s50, 57344
  buffer_load_dwordx4 v8, s[8:11], s48 offen lds
  v_exp_f32 v94, v94
  v_cvt_pk_bf16_f32 v109, v90, v91
  v_exp_f32 v95, v95
  s_waitcnt vmcnt(5)
  v_mfma_f32_32x32x16_bf16 v[32:47], v[152:155], v[104:107], v[32:47]
  v_exp_f32 v64, v64
  v_cvt_pk_bf16_f32 v110, v92, v93
  v_exp_f32 v65, v65
  v_exp_f32 v66, v66
  v_cvt_pk_bf16_f32 v111, v94, v95
  v_exp_f32 v67, v67
  v_mfma_f32_32x32x16_bf16 v[80:95], v[136:139], v[16:19], 0
  v_exp_f32 v68, v68
  v_cvt_pk_bf16_f32 v96, v64, v65
  v_exp_f32 v69, v69
  s_add_u32 m0, s51, 24576
  s_add_u32 s48, s50, 86016
  buffer_load_dwordx4 v8, s[8:11], s48 offen lds
  v_exp_f32 v70, v70
  v_cvt_pk_bf16_f32 v97, v66, v67
  v_exp_f32 v71, v71
  v_mfma_f32_32x32x16_bf16 v[80:95], v[140:143], v[20:23], v[80:95]
  v_exp_f32 v72, v72
  v_cvt_pk_bf16_f32 v98, v68, v69
  v_exp_f32 v73, v73
  s_add_u32 m0, s51, 32768
  s_add_u32 s48, s50, 114688
  buffer_load_dwordx4 v8, s[8:11], s48 offen lds
  v_exp_f32 v74, v74
  v_cvt_pk_bf16_f32 v99, v70, v71
  v_exp_f32 v75, v75
  v_mfma_f32_32x32x16_bf16 v[32:47], v[156:159], v[108:111], v[32:47]
  v_exp_f32 v76, v76
  v_cvt_pk_bf16_f32 v100, v72, v73
  v_exp_f32 v77, v77
  s_add_u32 m0, s51, 40960
  s_add_u32 s48, s50, 143360
  buffer_load_dwordx4 v8, s[8:11], s48 offen lds
  v_exp_f32 v78, v78
  v_cvt_pk_bf16_f32 v101, v74, v75
  v_exp_f32 v79, v79
  v_mfma_f32_32x32x16_bf16 v[32:47], v[160:163], v[96:99], v[32:47]
  v_exp_f32 v80, v80
  v_cvt_pk_bf16_f32 v102, v76, v77
  v_exp_f32 v81, v81
  v_exp_f32 v82, v82
  v_cvt_pk_bf16_f32 v103, v78, v79
  v_exp_f32 v83, v83
  v_mfma_f32_32x32x16_bf16 v[64:79], v[112:115], v[24:27], 0
  v_exp_f32 v84, v84
  v_cvt_pk_bf16_f32 v104, v80, v81
  v_exp_f32 v85, v85
  s_add_u32 m0, s51, 49152
  s_add_u32 s48, s50, 172032
  buffer_load_dwordx4 v8, s[8:11], s48 offen lds
  v_exp_f32 v86, v86
  v_cvt_pk_bf16_f32 v105, v82, v83
  v_exp_f32 v87, v87
  v_mfma_f32_32x32x16_bf16 v[64:79], v[116:119], v[28:31], v[64:79]
  v_exp_f32 v88, v88
  v_cvt_pk_bf16_f32 v106, v84, v85
  v_exp_f32 v89, v89
  s_add_u32 m0, s51, 57344
  s_add_u32 s48, s50, 200704
  buffer_load_dwordx4 v8, s[8:11], s48 offen lds
  v_exp_f32 v90, v90
  v_cvt_pk_bf16_f32 v107, v86, v87
  v_exp_f32 v91, v91
  v_mfma_f32_32x32x16_bf16 v[32:47], v[164:167], v[100:103], v[32:47]
  v_exp_f32 v92, v92
  v_cvt_pk_bf16_f32 v108, v88, v89
  v_exp_f32 v93, v93
  s_add_u32 m0, s51, 65536
  s_add_u32 s48, s50, 229376
  buffer_load_dwordx4 v8, s[8:11], s48 offen lds
  v_exp_f32 v94, v94
  v_cvt_pk_bf16_f32 v109, v90, v91
  v_exp_f32 v95, v95
  s_waitcnt vmcnt(9)
  s_setprio 0
  v_mfma_f32_32x32x16_bf16 v[32:47], v[168:171], v[104:107], v[32:47]
  v_exp_f32 v64, v64
  v_cvt_pk_bf16_f32 v110, v92, v93
  v_exp_f32 v65, v65
  v_exp_f32 v66, v66
  v_cvt_pk_bf16_f32 v111, v94, v95
  v_exp_f32 v67, v67
  v_mfma_f32_32x32x16_bf16 v[80:95], v[120:123], v[24:27], 0
  v_exp_f32 v68, v68
  v_cvt_pk_bf16_f32 v96, v64, v65
  v_exp_f32 v69, v69
  s_add_u32 m0, s51, 73728
  s_add_u32 s48, s50, 258048
  buffer_load_dwordx4 v8, s[8:11], s48 offen lds
  v_exp_f32 v70, v70
  v_cvt_pk_bf16_f32 v97, v66, v67
  v_exp_f32 v71, v71
  v_mfma_f32_32x32x16_bf16 v[80:95], v[124:127], v[28:31], v[80:95]
  v_exp_f32 v72, v72
  v_cvt_pk_bf16_f32 v98, v68, v69
  v_exp_f32 v73, v73
  s_add_u32 m0, s51, 81920
  s_add_u32 s48, s50, 286720
  buffer_load_dwordx4 v8, s[8:11], s48 offen lds
  v_exp_f32 v74, v74
  v_cvt_pk_bf16_f32 v99, v70, v71
  v_exp_f32 v75, v75
  v_mfma_f32_32x32x16_bf16 v[32:47], v[172:175], v[108:111], v[32:47]
  v_exp_f32 v76, v76
  v_cvt_pk_bf16_f32 v100, v72, v73
  v_exp_f32 v77, v77
  s_cmp_eq_u32 s3, 7
  s_cselect_b32 s49, 10, 11
  s_lshl_b32 s48, s49, 13
  s_add_u32 m0, s51, s48
  s_mul_i32 s48, s49, 28672
  s_add_u32 s48, s48, s50
  buffer_load_dwordx4 v8, s[8:11], s48 offen lds
  v_exp_f32 v78, v78
  v_cvt_pk_bf16_f32 v101, v74, v75
  v_exp_f32 v79, v79
  v_mfma_f32_32x32x16_bf16 v[48:63], v[144:147], v[96:99], v[48:63]
  v_exp_f32 v80, v80
  v_cvt_pk_bf16_f32 v102, v76, v77
  v_exp_f32 v81, v81
  v_exp_f32 v82, v82
  v_cvt_pk_bf16_f32 v103, v78, v79
  v_exp_f32 v83, v83
  v_mfma_f32_32x32x16_bf16 v[64:79], v[128:131], v[24:27], 0
  v_exp_f32 v84, v84
  v_cvt_pk_bf16_f32 v104, v80, v81
  v_exp_f32 v85, v85
  v_exp_f32 v86, v86
  v_cvt_pk_bf16_f32 v105, v82, v83
  v_exp_f32 v87, v87
  v_mfma_f32_32x32x16_bf16 v[64:79], v[132:135], v[28:31], v[64:79]
  v_exp_f32 v88, v88
  v_cvt_pk_bf16_f32 v106, v84, v85
  v_exp_f32 v89, v89
  v_exp_f32 v90, v90
  v_cvt_pk_bf16_f32 v107, v86, v87
  v_exp_f32 v91, v91
  v_mfma_f32_32x32x16_bf16 v[48:63], v[148:151], v[100:103], v[48:63]
  v_exp_f32 v92, v92
  v_cvt_pk_bf16_f32 v108, v88, v89
  v_exp_f32 v93, v93
  v_exp_f32 v94, v94
  v_cvt_pk_bf16_f32 v109, v90, v91
  v_exp_f32 v95, v95
  v_mfma_f32_32x32x16_bf16 v[48:63], v[152:155], v[104:107], v[48:63]
  v_exp_f32 v64, v64
  v_cvt_pk_bf16_f32 v110, v92, v93
  v_exp_f32 v65, v65
  v_exp_f32 v66, v66
  v_cvt_pk_bf16_f32 v111, v94, v95
  v_exp_f32 v67, v67
  v_mfma_f32_32x32x16_bf16 v[80:95], v[136:139], v[24:27], 0
  v_exp_f32 v68, v68
  v_cvt_pk_bf16_f32 v96, v64, v65
  v_exp_f32 v69, v69
  ds_write_b128 v240, v[32:35] offset:0
  v_exp_f32 v70, v70
  v_cvt_pk_bf16_f32 v97, v66, v67
  v_exp_f32 v71, v71
  v_mfma_f32_32x32x16_bf16 v[80:95], v[140:143], v[28:31], v[80:95]
  v_exp_f32 v72, v72
  v_cvt_pk_bf16_f32 v98, v68, v69
  v_exp_f32 v73, v73
  v_exp_f32 v74, v74
  v_cvt_pk_bf16_f32 v99, v70, v71
  v_exp_f32 v75, v75
  v_mfma_f32_32x32x16_bf16 v[48:63], v[156:159], v[108:111], v[48:63]
  v_exp_f32 v76, v76
  v_cvt_pk_bf16_f32 v100, v72, v73
  v_exp_f32 v77, v77
  ds_write_b128 v240, v[36:39] offset:1024
  v_exp_f32 v78, v78
  v_cvt_pk_bf16_f32 v101, v74, v75
  v_exp_f32 v79, v79
  v_mfma_f32_32x32x16_bf16 v[48:63], v[160:163], v[96:99], v[48:63]
  v_exp_f32 v80, v80
  v_cvt_pk_bf16_f32 v102, v76, v77
  v_exp_f32 v81, v81
  v_exp_f32 v82, v82
  v_cvt_pk_bf16_f32 v103, v78, v79
  v_exp_f32 v83, v83
  v_exp_f32 v84, v84
  v_cvt_pk_bf16_f32 v104, v80, v81
  v_exp_f32 v85, v85
  ds_write_b128 v240, v[40:43] offset:4096
  v_exp_f32 v86, v86
  v_cvt_pk_bf16_f32 v105, v82, v83
  v_exp_f32 v87, v87
  v_exp_f32 v88, v88
  v_cvt_pk_bf16_f32 v106, v84, v85
  v_exp_f32 v89, v89
  v_exp_f32 v90, v90
  v_cvt_pk_bf16_f32 v107, v86, v87
  v_exp_f32 v91, v91
  v_mfma_f32_32x32x16_bf16 v[48:63], v[164:167], v[100:103], v[48:63]
  v_exp_f32 v92, v92
  v_cvt_pk_bf16_f32 v108, v88, v89
  v_exp_f32 v93, v93
  ds_write_b128 v240, v[44:47] offset:5120
  v_exp_f32 v94, v94
  v_cvt_pk_bf16_f32 v109, v90, v91
  v_exp_f32 v95, v95
A_exit:
  s_setprio 0
  v_cvt_pk_bf16_f32 v110, v92, v93
  v_cvt_pk_bf16_f32 v111, v94, v95
  v_mfma_f32_32x32x16_bf16 v[48:63], v[168:171], v[104:107], v[48:63]
  s_nop 0
  v_mfma_f32_32x32x16_bf16 v[48:63], v[172:175], v[108:111], v[48:63]
  s_mov_b32 s94, 0
  s_cmp_ge_u32 s23, 28
  s_nop 8
  s_cbranch_scc1 A_red2
  s_cmp_lt_u32 s3, 4
  s_cbranch_scc1 A_red2
  v_xor_b32 v196, s20, v196
  v_xor_b32 v197, s20, v197
  v_xor_b32 v198, s20, v198
  v_xor_b32 v199, s20, v199
  v_or3_b32 v196, v196, v197, v198
  v_or_b32 v196, v196, v199
  v_cmp_ne_u32 vcc, 0, v196
  s_add_u32 s92, s93, 16
  s_nop 3
  s_cbranch_vccz A_y
  s_mov_b32 s62, 0
PL_f3:
  buffer_load_dwordx4 v[196:199], v238, s[16:19], 0 offen sc1
  s_waitcnt vmcnt(0)
  v_xor_b32 v196, s20, v196
  v_xor_b32 v197, s20, v197
  v_xor_b32 v198, s20, v198
  v_xor_b32 v199, s20, v199
  v_or3_b32 v196, v196, v197, v198
  v_or_b32 v196, v196, v199
  v_cmp_ne_u32 vcc, 0, v196
  s_nop 4
  s_cbranch_vccz PL_f3_ok
  s_sleep 4
  s_add_u32 s62, s62, 1
  s_cmp_lt_u32 s62, 1000000
  s_cbranch_scc1 PL_f3
PL_f3_ok:
  s_mov_b64 exec, -1
A_y:
  buffer_load_dwordx4 v[196:199], v239, s[16:19], s93 offen
  buffer_load_dwordx4 v[212:215], v239, s[16:19], s92 offen
A_red2:
  ds_write_b128 v240, v[48:51] offset:8192
  ds_write_b128 v240, v[52:55] offset:9216
  ds_write_b128 v240, v[56:59] offset:12288
  ds_write_b128 v240, v[60:63] offset:13312
  s_waitcnt lgkmcnt(0)
  s_barrier
  ds_read_b32 v12, v242 offset:0
  ds_read_b32 v13, v242 offset:2048
  ds_read_b32 v14, v242 offset:32768
  ds_read_b32 v15, v242 offset:34816
  ds_read_b128 v[64:67], v241 offset:0
  ds_read_b128 v[68:71], v241 offset:1024
  ds_read_b128 v[72:75], v241 offset:2048
  ds_read_b128 v[76:79], v241 offset:3072
  ds_read_b128 v[80:83], v241 offset:32768
  ds_read_b128 v[84:87], v241 offset:33792
  ds_read_b128 v[88:91], v241 offset:34816
  ds_read_b128 v[92:95], v241 offset:35840
  s_waitcnt lgkmcnt(8)
  v_add_f32 v12, v12, v13
  v_add_f32 v14, v14, v15
  v_add_f32 v12, v12, v14
  v_rcp_f32 v12, v12
  s_waitcnt lgkmcnt(0)
  v_cndmask_b32 v13, v12, 0, s[100:101]
  v_pk_add_f32 v[64:65], v[64:65], v[72:73]
  v_pk_add_f32 v[80:81], v[80:81], v[88:89]
  v_pk_add_f32 v[66:67], v[66:67], v[74:75]
  v_pk_add_f32 v[82:83], v[82:83], v[90:91]
  v_pk_add_f32 v[68:69], v[68:69], v[76:77]
  v_pk_add_f32 v[84:85], v[84:85], v[92:93]
  v_pk_add_f32 v[70:71], v[70:71], v[78:79]
  v_pk_add_f32 v[86:87], v[86:87], v[94:95]
  v_pk_add_f32 v[64:65], v[64:65], v[80:81]
  v_pk_add_f32 v[66:67], v[66:67], v[82:83]
  v_pk_add_f32 v[68:69], v[68:69], v[84:85]
  v_pk_add_f32 v[70:71], v[70:71], v[86:87]
  v_pk_mul_f32 v[64:65], v[64:65], v[12:13] op_sel:[0,0] op_sel_hi:[1,0]
  v_pk_mul_f32 v[66:67], v[66:67], v[12:13] op_sel:[0,0] op_sel_hi:[1,0]
  v_pk_mul_f32 v[68:69], v[68:69], v[12:13] op_sel:[0,1] op_sel_hi:[1,1]
  v_pk_mul_f32 v[70:71], v[70:71], v[12:13] op_sel:[0,1] op_sel_hi:[1,1]
  v_cvt_pk_bf16_f32 v72, v64, v65
  v_cvt_pk_bf16_f32 v73, v66, v67
  v_cvt_pk_bf16_f32 v74, v68, v69
  v_cvt_pk_bf16_f32 v75, v70, v71
  buffer_store_dwordx4 v[72:75], v2, s[16:19], s4 offen sc1
  ds_read_b32 v80, v243 offset:0
  ds_read_b32 v81, v243 offset:2048
  ds_read_b32 v82, v243 offset:32768
  ds_read_b32 v83, v243 offset:34816
  ds_read_b32 v84, v243 offset:16384
  ds_read_b32 v85, v243 offset:18432
  ds_read_b32 v86, v243 offset:49152
  ds_read_b32 v87, v243 offset:51200
  s_mov_b32 s36, 813694976
  s_mov_b32 s37, 1400897536
  s_waitcnt lgkmcnt(0)
  v_add_f32 v80, v80, v81
  v_add_f32 v82, v82, v83
  v_add_f32 v84, v84, v85
  v_add_f32 v86, v86, v87
  v_add_f32 v80, v80, v82
  v_add_f32 v84, v84, v86
  v_cmp_nle_f32 vcc, s36, v80
  v_cmp_nge_f32 s[42:43], s37, v80
  v_cmp_nle_f32 s[44:45], s36, v84
  v_cmp_nge_f32 s[60:61], s37, v84
  s_or_b64 s[42:43], s[42:43], vcc
  s_or_b64 s[44:45], s[44:45], s[60:61]
  s_or_b64 s[42:43], s[42:43], s[44:45]
  s_cbranch_scc1 A_slow
A_done:
  s_and_b32 s29, s3, 3
  v_mov_b32 v15, 118784
  s_cmp_ge_u32 s3, 4
  s_cbranch_scc1 P_fetch
  s_lshl_b32 s36, s41, 11
  s_lshr_b32 s37, s40, 2
  s_lshl_b32 s37, s37, 7
  s_add_u32 s36, s36, s37
  s_and_b32 s37, s40, 3
  s_lshl_b32 s37, s37, 2
  s_add_u32 s36, s36, s37
  s_add_u32 s36, s36, 65536
  v_lshl_add_u32 v28, v1, 9, s36
  v_mov_b32 v29, s20
  v_bfe_u32 v7, v1, 2, 2
  v_xor_b32 v12, s29, v7
  v_lshlrev_b32 v12, 6, v12
  v_bfe_u32 v9, v1, 4, 1
  v_lshl_add_u32 v12, v9, 5, v12
  v_and_b32 v9, 3, v1
  v_lshl_add_u32 v12, v9, 3, v12
  v_lshl_add_u32 v9, v6, 2, v7
  v_lshl_add_u32 v12, v9, 8, v12
  v_add_u32 v13, 57344, v12
  s_waitcnt vmcnt(0)
  s_barrier
  s_lshl_b64 exec, 1, s3
  buffer_store_dword v29, v28, s[16:19], 0 offen sc1
  s_mov_b64 exec, -1
  ds_read_b64_tr_b16 v[32:33], v12 offset:0
  ds_read_b64_tr_b16 v[34:35], v12 offset:2048
  ds_read_b64_tr_b16 v[36:37], v12 offset:4096
  ds_read_b64_tr_b16 v[38:39], v12 offset:6144
  ds_read_b64_tr_b16 v[40:41], v12 offset:7168
  ds_read_b64_tr_b16 v[42:43], v12 offset:9216
  ds_read_b64_tr_b16 v[44:45], v12 offset:11264
  ds_read_b64_tr_b16 v[46:47], v12 offset:13312
  ds_read_b64_tr_b16 v[48:49], v12 offset:14336
  ds_read_b64_tr_b16 v[50:51], v12 offset:16384
  ds_read_b64_tr_b16 v[52:53], v12 offset:18432
  ds_read_b64_tr_b16 v[54:55], v12 offset:20480
  ds_read_b64_tr_b16 v[56:57], v12 offset:21504
  ds_read_b64_tr_b16 v[58:59], v12 offset:23552
  ds_read_b64_tr_b16 v[60:61], v12 offset:25600
  ds_read_b64_tr_b16 v[62:63], v12 offset:27648
  ds_read_b64_tr_b16 v[64:65], v12 offset:28672
  ds_read_b64_tr_b16 v[66:67], v12 offset:30720
  ds_read_b64_tr_b16 v[68:69], v12 offset:32768
  ds_read_b64_tr_b16 v[70:71], v12 offset:34816
  ds_read_b64_tr_b16 v[72:73], v12 offset:35840
  ds_read_b64_tr_b16 v[74:75], v12 offset:37888
  ds_read_b64_tr_b16 v[76:77], v12 offset:39936
  ds_read_b64_tr_b16 v[78:79], v12 offset:41984
  ds_read_b64_tr_b16 v[80:81], v12 offset:43008
  ds_read_b64_tr_b16 v[82:83], v12 offset:45056
  ds_read_b64_tr_b16 v[84:85], v12 offset:47104
  ds_read_b64_tr_b16 v[86:87], v12 offset:49152
  ds_read_b64_tr_b16 v[88:89], v12 offset:50176
  ds_read_b64_tr_b16 v[90:91], v12 offset:52224
  ds_read_b64_tr_b16 v[92:93], v12 offset:54272
  ds_read_b64_tr_b16 v[94:95], v12 offset:56320
  ds_read_b64_tr_b16 v[96:97], v13 offset:0
  ds_read_b64_tr_b16 v[98:99], v13 offset:2048
  ds_read_b64_tr_b16 v[100:101], v13 offset:4096
  ds_read_b64_tr_b16 v[102:103], v13 offset:6144
  ds_read_b64_tr_b16 v[104:105], v13 offset:7168
  ds_read_b64_tr_b16 v[106:107], v13 offset:9216
  ds_read_b64_tr_b16 v[108:109], v13 offset:11264
  ds_read_b64_tr_b16 v[110:111], v13 offset:13312
  ds_read_b64_tr_b16 v[112:113], v13 offset:14336
  ds_read_b64_tr_b16 v[114:115], v13 offset:16384
  ds_read_b64_tr_b16 v[116:117], v13 offset:18432
  ds_read_b64_tr_b16 v[118:119], v13 offset:20480
  ds_read_b64_tr_b16 v[120:121], v13 offset:21504
  ds_read_b64_tr_b16 v[122:123], v13 offset:23552
  ds_read_b64_tr_b16 v[124:125], v13 offset:25600
  ds_read_b64_tr_b16 v[126:127], v13 offset:27648
  ds_read_b64_tr_b16 v[128:129], v13 offset:28672
  ds_read_b64_tr_b16 v[130:131], v13 offset:30720
  ds_read_b64_tr_b16 v[132:133], v13 offset:32768
  ds_read_b64_tr_b16 v[134:135], v13 offset:34816
  v_add_u32 v10, 122880, v2
  s_lshl_b32 s36, s52, 5
  v_add_u32 v11, s36, v5
  v_mul_u32_u24 v11, 1792, v11
  v_lshl_add_u32 v11, v6, 4, v11
  s_lshl_b32 s30, s53, 2
  s_add_u32 s30, s30, s29
  s_lshl_b32 s32, s30, 6
  s_cmp_ge_u32 s30, 14
  s_cbranch_scc1 P_fin
  v_lshl_add_u32 v14, v1, 2, v15
  ds_read_b32 v28, v14
  s_waitcnt lgkmcnt(0)
P_n0:
  v_cmp_eq_u32 vcc, s20, v28
  s_nop 1
  s_bitcmp1_b32 vcc_lo, 0
  s_cbranch_scc0 P_r0
P_g0:
  ds_read_b128 v[160:163], v10 offset:0
  ds_read_b128 v[164:167], v10 offset:1024
  ds_read_b128 v[168:171], v10 offset:2048
  ds_read_b128 v[172:175], v10 offset:3072
  ds_read_b128 v[176:179], v10 offset:4096
  ds_read_b128 v[180:183], v10 offset:5120
  ds_read_b128 v[184:187], v10 offset:6144
  ds_read_b128 v[188:191], v10 offset:7168
  ds_read_b32 v28, v14
  s_waitcnt lgkmcnt(0)
P_n1:
  v_cmp_eq_u32 vcc, s20, v28
  s_nop 1
  s_bitcmp1_b32 vcc_lo, 1
  s_cbranch_scc0 P_r1
P_g1:
  ds_read_b128 v[192:195], v10 offset:8192
  ds_read_b128 v[196:199], v10 offset:9216
  ds_read_b128 v[200:203], v10 offset:10240
  ds_read_b128 v[204:207], v10 offset:11264
  ds_read_b128 v[208:211], v10 offset:12288
  ds_read_b128 v[212:215], v10 offset:13312
  ds_read_b128 v[216:219], v10 offset:14336
  ds_read_b128 v[220:223], v10 offset:15360
  ds_read_b32 v28, v14
  v_mfma_f32_32x32x16_bf16 v[224:239], v[32:35], v[160:163], 0
  v_mfma_f32_32x32x16_bf16 v[224:239], v[36:39], v[164:167], v[224:239]
  v_mfma_f32_32x32x16_bf16 v[224:239], v[40:43], v[168:171], v[224:239]
  v_mfma_f32_32x32x16_bf16 v[224:239], v[44:47], v[172:175], v[224:239]
  v_mfma_f32_32x32x16_bf16 v[224:239], v[48:51], v[176:179], v[224:239]
  v_mfma_f32_32x32x16_bf16 v[224:239], v[52:55], v[180:183], v[224:239]
  v_mfma_f32_32x32x16_bf16 v[224:239], v[56:59], v[184:187], v[224:239]
  v_mfma_f32_32x32x16_bf16 v[224:239], v[60:63], v[188:191], v[224:239]
  s_waitcnt lgkmcnt(0)
P_n2:
  v_cmp_eq_u32 vcc, s20, v28
  s_nop 1
  s_bitcmp1_b32 vcc_lo, 2
  s_cbranch_scc0 P_r2
P_g2:
  ds_read_b128 v[160:163], v10 offset:16384
  ds_read_b128 v[164:167], v10 offset:17408
  ds_read_b128 v[168:171], v10 offset:18432
  ds_read_b128 v[172:175], v10 offset:19456
  ds_read_b128 v[176:179], v10 offset:20480
  ds_read_b128 v[180:183], v10 offset:21504
  ds_read_b128 v[184:187], v10 offset:22528
  ds_read_b128 v[188:191], v10 offset:23552
  ds_read_b32 v28, v14
  v_mfma_f32_32x32x16_bf16 v[224:239], v[64:67], v[192:195], v[224:239]
  v_mfma_f32_32x32x16_bf16 v[224:239], v[68:71], v[196:199], v[224:239]
  v_mfma_f32_32x32x16_bf16 v[224:239], v[72:75], v[200:203], v[224:239]
  v_mfma_f32_32x32x16_bf16 v[224:239], v[76:79], v[204:207], v[224:239]
  v_mfma_f32_32x32x16_bf16 v[224:239], v[80:83], v[208:211], v[224:239]
  v_mfma_f32_32x32x16_bf16 v[224:239], v[84:87], v[212:215], v[224:239]
  v_mfma_f32_32x32x16_bf16 v[224:239], v[88:91], v[216:219], v[224:239]
  v_mfma_f32_32x32x16_bf16 v[224:239], v[92:95], v[220:223], v[224:239]
  s_waitcnt lgkmcnt(0)
P_n3:
  v_cmp_eq_u32 vcc, s20, v28
  s_nop 1
  s_bitcmp1_b32 vcc_lo, 3
  s_cbranch_scc0 P_r3
P_g3:
  ds_read_b128 v[192:195], v10 offset:24576
  ds_read_b128 v[196:199], v10 offset:25600
  ds_read_b128 v[200:203], v10 offset:26624
  ds_read_b128 v[204:207], v10 offset:27648
  ds_read_b128 v[208:211], v10 offset:28672
  ds_read_b128 v[212:215], v10 offset:29696
  ds_read_b128 v[216:219], v10 offset:30720
  ds_read_b128 v[220:223], v10 offset:31744
  ds_read_b64_tr_b16 v[136:137], v13 offset:35840
  ds_read_b64_tr_b16 v[138:139], v13 offset:37888
  ds_read_b64_tr_b16 v[140:141], v13 offset:39936
  ds_read_b64_tr_b16 v[142:143], v13 offset:41984
  ds_read_b64_tr_b16 v[144:145], v13 offset:43008
  ds_read_b64_tr_b16 v[146:147], v13 offset:45056
  ds_read_b64_tr_b16 v[148:149], v13 offset:47104
  ds_read_b64_tr_b16 v[150:151], v13 offset:49152
  ds_read_b64_tr_b16 v[152:153], v13 offset:50176
  ds_read_b64_tr_b16 v[154:155], v13 offset:52224
  ds_read_b64_tr_b16 v[156:157], v13 offset:54272
  ds_read_b64_tr_b16 v[158:159], v13 offset:56320
  v_mfma_f32_32x32x16_bf16 v[224:239], v[96:99], v[160:163], v[224:239]
  v_mfma_f32_32x32x16_bf16 v[224:239], v[100:103], v[164:167], v[224:239]
  v_mfma_f32_32x32x16_bf16 v[224:239], v[104:107], v[168:171], v[224:239]
  v_mfma_f32_32x32x16_bf16 v[224:239], v[108:111], v[172:175], v[224:239]
  v_mfma_f32_32x32x16_bf16 v[224:239], v[112:115], v[176:179], v[224:239]
  v_mfma_f32_32x32x16_bf16 v[224:239], v[116:119], v[180:183], v[224:239]
  v_mfma_f32_32x32x16_bf16 v[224:239], v[120:123], v[184:187], v[224:239]
  v_mfma_f32_32x32x16_bf16 v[224:239], v[124:127], v[188:191], v[224:239]
  s_waitcnt lgkmcnt(0)
  v_mfma_f32_32x32x16_bf16 v[224:239], v[128:131], v[192:195], v[224:239]
  v_mfma_f32_32x32x16_bf16 v[224:239], v[132:135], v[196:199], v[224:239]
  v_mfma_f32_32x32x16_bf16 v[224:239], v[136:139], v[200:203], v[224:239]
  v_mfma_f32_32x32x16_bf16 v[224:239], v[140:143], v[204:207], v[224:239]
  v_mfma_f32_32x32x16_bf16 v[224:239], v[144:147], v[208:211], v[224:239]
  v_mfma_f32_32x32x16_bf16 v[224:239], v[148:151], v[212:215], v[224:239]
  v_mfma_f32_32x32x16_bf16 v[224:239], v[152:155], v[216:219], v[224:239]
  v_mfma_f32_32x32x16_bf16 v[224:239], v[156:159], v[220:223], v[224:239]
P_epi:
  s_nop 11
  v_cvt_pk_bf16_f32 v40, v224, v225
  v_cvt_pk_bf16_f32 v41, v226, v227
  v_cvt_pk_bf16_f32 v42, v228, v229
  v_cvt_pk_bf16_f32 v43, v230, v231
  v_cvt_pk_bf16_f32 v44, v232, v233
  v_cvt_pk_bf16_f32 v45, v234, v235
  v_cvt_pk_bf16_f32 v46, v236, v237
  v_cvt_pk_bf16_f32 v47, v238, v239
  v_permlane32_swap_b32 v40, v42
  v_permlane32_swap_b32 v41, v43
  v_permlane32_swap_b32 v44, v46
  v_permlane32_swap_b32 v45, v47
  buffer_store_dwordx4 v[40:43], v11, s[12:15], s32 offen nt
  buffer_store_dwordx4 v[44:47], v11, s[12:15], s32 offen offset:32 nt
  s_branch P_fin
P_r0:
  ds_read_b32 v28, v14
  s_add_u32 s95, s95, 1
  s_cmp_lt_u32 s95, 0x2000000
  s_waitcnt lgkmcnt(0)
  s_cbranch_scc1 P_n0
  s_branch P_g0
P_r1:
  ds_read_b32 v28, v14
  s_add_u32 s95, s95, 1
  s_cmp_lt_u32 s95, 0x2000000
  s_waitcnt lgkmcnt(0)
  s_cbranch_scc1 P_n1
  s_branch P_g1
P_r2:
  ds_read_b32 v28, v14
  s_add_u32 s95, s95, 1
  s_cmp_lt_u32 s95, 0x2000000
  s_waitcnt lgkmcnt(0)
  s_cbranch_scc1 P_n2
  s_branch P_g2
P_r3:
  ds_read_b32 v28, v14
  s_add_u32 s95, s95, 1
  s_cmp_lt_u32 s95, 0x2000000
  s_waitcnt lgkmcnt(0)
  s_cbranch_scc1 P_n3
  s_branch P_g3
P_fetch:
  s_lshl_b32 s37, s52, 9
  s_lshl_b32 s38, s29, 7
  s_add_u32 s37, s37, s38
  s_add_u32 s37, s37, 65536
  v_lshl_add_u32 v16, v1, 2, s37
  s_mov_b64 exec, 0xf
  buffer_load_dword v17, v16, s[16:19], 0 offen sc1
  s_mov_b64 exec, -1
  s_lshl_b32 s38, s52, 15
  s_lshl_b32 s39, s29, 13
  s_add_u32 s38, s38, s39
  s_add_u32 s38, s38, 5636096
  s_add_u32 s39, s39, 122880
  s_lshl_b32 s37, s29, 2
  v_add_u32 v15, s37, v15
  v_mov_b32 v14, s20
  s_waitcnt vmcnt(1)
  s_barrier
  s_waitcnt vmcnt(0)
  v_cmp_ne_u32 s[44:45], s20, v17
  s_cmp_lg_u32 s3, 7
  s_cbranch_scc1 P_nowo
  s_mov_b32 s48, 97280
  s_mov_b32 s50, 340480
P_wo:
  s_mov_b32 m0, s48
  s_add_u32 s48, s48, 1024
  buffer_load_dwordx4 v8, s[8:11], s50 offen lds
  s_add_u32 s50, s50, 3584
  s_cmp_le_u32 s50, 401408
  s_cbranch_scc1 P_wo
P_nowo:
  s_and_b32 s44, s44, 15
  s_cbranch_scc0 PL_f2_ok
  s_mov_b32 exec_lo, 15
  s_mov_b32 exec_hi, 0
  s_mov_b32 s62, 0
PL_f2:
  buffer_load_dword v17, v16, s[16:19], 0 offen sc1
  s_waitcnt vmcnt(0)
  v_cmp_ne_u32 vcc, s20, v17
  s_nop 4
  s_cbranch_vccz PL_f2_ok
  s_sleep 1
  s_add_u32 s62, s62, 1
  s_cmp_lt_u32 s62, 1000000
  s_cbranch_scc1 PL_f2
PL_f2_ok:
  s_mov_b64 exec, -1
  s_add_u32 m0, s39, 0
  s_nop 0
  buffer_load_dwordx4 v2, s[16:19], s38 offen offset:0 sc1 lds
  buffer_load_dwordx4 v2, s[16:19], s38 offen offset:1024 sc1 lds
  buffer_load_dwordx4 v2, s[16:19], s38 offen offset:2048 sc1 lds
  buffer_load_dwordx4 v2, s[16:19], s38 offen offset:3072 sc1 lds
  s_add_u32 m0, s39, 4096
  s_add_u32 s38, s38, 4096
  buffer_load_dwordx4 v2, s[16:19], s38 offen offset:0 sc1 lds
  buffer_load_dwordx4 v2, s[16:19], s38 offen offset:1024 sc1 lds
  buffer_load_dwordx4 v2, s[16:19], s38 offen offset:2048 sc1 lds
  buffer_load_dwordx4 v2, s[16:19], s38 offen offset:3072 sc1 lds
  s_waitcnt vmcnt(0)
  ds_write_b32 v15, v14
  s_cmp_ge_u32 s23, 28
  s_cbranch_scc1 P_noy
  s_lshl_b32 s36, s29, 11
  s_add_u32 s36, s36, 155648
  v_add_u32 v203, s36, v2
  ds_write_b128 v203, v[196:199]
  ds_write_b128 v203, v[212:215] offset:1024
  v_lshrrev_b32 v17, 4, v1
  v_and_b32 v18, 3, v1
  v_lshl_add_u32 v17, v17, 2, v18
  v_and_b32 v18, 7, v17
  v_lshrrev_b32 v17, 3, v17
  v_bfe_u32 v19, v1, 2, 2
  v_lshl_add_u32 v18, v18, 3, v19
  v_lshlrev_b32 v18, 4, v18
  v_lshl_add_u32 v18, v17, 3, v18
  v_add_u32 v204, s36, v18
  s_waitcnt lgkmcnt(0)
  ds_read_b64_tr_b16 v[208:209], v204
  ds_read_b64_tr_b16 v[210:211], v204 offset:64
  ds_read_b64_tr_b16 v[216:217], v204 offset:1024
  ds_read_b64_tr_b16 v[218:219], v204 offset:1088
  v_and_b32 v19, 3, v1
  v_lshl_add_u32 v19, v6, 2, v19
  s_lshl_b32 s36, s26, 6
  s_lshl_b32 s37, s29, 4
  s_add_u32 s36, s36, s37
  v_add_u32 v19, s36, v19
  v_mul_u32_u24 v19, 1792, v19
  v_bfe_u32 v17, v1, 2, 3
  v_lshl_add_u32 v205, v17, 4, v19
  s_lshl_b32 s93, s25, 7
  s_add_u32 s93, s93, 896
  s_add_u32 s92, s93, 14336
  s_waitcnt lgkmcnt(0)
  buffer_store_dwordx4 v[208:211], v205, s[12:15], s93 offen nt
  buffer_store_dwordx4 v[216:219], v205, s[12:15], s92 offen nt
P_noy:
  s_cmp_lg_u32 s2, 240
  s_cbranch_scc1 P_fin
  s_cmp_lg_u32 s3, 4
  s_cbranch_scc1 P_fin
  v_lshlrev_b32 v16, 7, v5
  v_add_u32 v16, 94208, v16
  s_mov_b32 s62, 0
PL_ep:
  buffer_load_dwordx4 v[20:23], v16, s[16:19], 0 offen sc1
  s_waitcnt vmcnt(0)
  v_xor_b32 v20, s20, v20
  v_xor_b32 v21, s20, v21
  v_xor_b32 v22, s20, v22
  v_xor_b32 v23, s20, v23
  v_or3_b32 v20, v20, v21, v22
  v_or_b32 v20, v20, v23
  v_cmp_ne_u32 vcc, 0, v20
  s_nop 4
  s_cbranch_vccz PL_ep_ok
  s_sleep 2
  s_add_u32 s62, s62, 1
  s_cmp_lt_u32 s62, 1000000
  s_cbranch_scc1 PL_ep
PL_ep_ok:
  s_mov_b64 exec, -1
  s_mov_b32 s36, 98304
  v_mov_b32 v16, s36
  v_mov_b32 v17, s20
  s_mov_b64 exec, 1
  buffer_store_dword v17, v16, s[16:19], 0 offen sc1
  s_mov_b64 exec, -1
P_fin:
L_end:
  s_endpgm
A_slow:
  s_cmp_lg_u32 s94, 0
  s_cbranch_scc1 A_done
  s_waitcnt vmcnt(0)
  s_barrier
  v_mov_b32 v192, 0xff800000
  v_mov_b32 v193, 0xff800000
  v_mov_b64 v[32:33], 0
  v_mov_b64 v[34:35], 0
  v_mov_b64 v[36:37], 0
  v_mov_b64 v[38:39], 0
  v_mov_b64 v[40:41], 0
  v_mov_b64 v[42:43], 0
  v_mov_b64 v[44:45], 0
  v_mov_b64 v[46:47], 0
  v_mov_b64 v[48:49], 0
  v_mov_b64 v[50:51], 0
  v_mov_b64 v[52:53], 0
  v_mov_b64 v[54:55], 0
  v_mov_b64 v[56:57], 0
  v_mov_b64 v[58:59], 0
  v_mov_b64 v[60:61], 0
  v_mov_b64 v[62:63], 0
AS_pass:
  s_mov_b32 s37, 0
AS_tile:
  buffer_load_dwordx4 v[112:115], v3, s[16:19], s33 offen
  buffer_load_dwordx4 v[116:119], v3, s[16:19], s33 offen offset:1024
  s_mov_b64 exec, s[46:47]
  buffer_load_dwordx4 v[144:147], v4, s[16:19], s33 offen
  buffer_load_dwordx4 v[148:151], v7, s[16:19], s33 offen
  s_mov_b64 exec, -1
  s_add_u32 s33, s33, 28672
  s_cmp_eq_u32 s33, s55
  s_cselect_b32 s33, s54, s33
  s_waitcnt vmcnt(0)
  v_mfma_f32_32x32x16_bf16 v[64:79], v[112:115], v[16:19], 0
  v_mfma_f32_32x32x16_bf16 v[64:79], v[116:119], v[20:23], v[64:79]
  v_mfma_f32_32x32x16_bf16 v[80:95], v[112:115], v[24:27], 0
  v_mfma_f32_32x32x16_bf16 v[80:95], v[116:119], v[28:31], v[80:95]
  s_nop 15
  s_cmp_lg_u32 s94, 0
  s_cbranch_scc1 AS_p1
  v_max3_f32 v192, v64, v65, v192
  v_max3_f32 v192, v66, v67, v192
  v_max3_f32 v192, v68, v69, v192
  v_max3_f32 v192, v70, v71, v192
  v_max3_f32 v192, v72, v73, v192
  v_max3_f32 v192, v74, v75, v192
  v_max3_f32 v192, v76, v77, v192
  v_max3_f32 v192, v78, v79, v192
  v_max3_f32 v193, v80, v81, v193
  v_max3_f32 v193, v82, v83, v193
  v_max3_f32 v193, v84, v85, v193
  v_max3_f32 v193, v86, v87, v193
  v_max3_f32 v193, v88, v89, v193
  v_max3_f32 v193, v90, v91, v193
  v_max3_f32 v193, v92, v93, v193
  v_max3_f32 v193, v94, v95, v193
  s_branch AS_next
AS_p1:
  v_sub_f32 v64, v64, v192
  v_sub_f32 v65, v65, v192
  v_sub_f32 v66, v66, v192
  v_sub_f32 v67, v67, v192
  v_sub_f32 v68, v68, v192
  v_sub_f32 v69, v69, v192
  v_sub_f32 v70, v70, v192
  v_sub_f32 v71, v71, v192
  v_sub_f32 v72, v72, v192
  v_sub_f32 v73, v73, v192
  v_sub_f32 v74, v74, v192
  v_sub_f32 v75, v75, v192
  v_sub_f32 v76, v76, v192
  v_sub_f32 v77, v77, v192
  v_sub_f32 v78, v78, v192
  v_sub_f32 v79, v79, v192
  v_exp_f32 v64, v64
  v_exp_f32 v65, v65
  v_exp_f32 v66, v66
  v_exp_f32 v67, v67
  v_exp_f32 v68, v68
  v_exp_f32 v69, v69
  v_exp_f32 v70, v70
  v_exp_f32 v71, v71
  v_exp_f32 v72, v72
  v_exp_f32 v73, v73
  v_exp_f32 v74, v74
  v_exp_f32 v75, v75
  v_exp_f32 v76, v76
  v_exp_f32 v77, v77
  v_exp_f32 v78, v78
  v_exp_f32 v79, v79
  v_cvt_pk_bf16_f32 v96, v64, v65
  v_cvt_pk_bf16_f32 v97, v66, v67
  v_cvt_pk_bf16_f32 v98, v68, v69
  v_cvt_pk_bf16_f32 v99, v70, v71
  v_cvt_pk_bf16_f32 v100, v72, v73
  v_cvt_pk_bf16_f32 v101, v74, v75
  v_cvt_pk_bf16_f32 v102, v76, v77
  v_cvt_pk_bf16_f32 v103, v78, v79
  v_mfma_f32_32x32x16_bf16 v[32:47], v[144:147], v[96:99], v[32:47]
  s_nop 0
  v_mfma_f32_32x32x16_bf16 v[32:47], v[148:151], v[100:103], v[32:47]
  v_sub_f32 v80, v80, v193
  v_sub_f32 v81, v81, v193
  v_sub_f32 v82, v82, v193
  v_sub_f32 v83, v83, v193
  v_sub_f32 v84, v84, v193
  v_sub_f32 v85, v85, v193
  v_sub_f32 v86, v86, v193
  v_sub_f32 v87, v87, v193
  v_sub_f32 v88, v88, v193
  v_sub_f32 v89, v89, v193
  v_sub_f32 v90, v90, v193
  v_sub_f32 v91, v91, v193
  v_sub_f32 v92, v92, v193
  v_sub_f32 v93, v93, v193
  v_sub_f32 v94, v94, v193
  v_sub_f32 v95, v95, v193
  v_exp_f32 v80, v80
  v_exp_f32 v81, v81
  v_exp_f32 v82, v82
  v_exp_f32 v83, v83
  v_exp_f32 v84, v84
  v_exp_f32 v85, v85
  v_exp_f32 v86, v86
  v_exp_f32 v87, v87
  v_exp_f32 v88, v88
  v_exp_f32 v89, v89
  v_exp_f32 v90, v90
  v_exp_f32 v91, v91
  v_exp_f32 v92, v92
  v_exp_f32 v93, v93
  v_exp_f32 v94, v94
  v_exp_f32 v95, v95
  v_cvt_pk_bf16_f32 v104, v80, v81
  v_cvt_pk_bf16_f32 v105, v82, v83
  v_cvt_pk_bf16_f32 v106, v84, v85
  v_cvt_pk_bf16_f32 v107, v86, v87
  v_cvt_pk_bf16_f32 v108, v88, v89
  v_cvt_pk_bf16_f32 v109, v90, v91
  v_cvt_pk_bf16_f32 v110, v92, v93
  v_cvt_pk_bf16_f32 v111, v94, v95
  v_mfma_f32_32x32x16_bf16 v[48:63], v[144:147], v[104:107], v[48:63]
  s_nop 0
  v_mfma_f32_32x32x16_bf16 v[48:63], v[148:151], v[108:111], v[48:63]
AS_next:
  s_nop 15
  s_add_u32 s37, s37, 1
  s_cmp_lt_u32 s37, s34
  s_cbranch_scc1 AS_tile
  s_cmp_lg_u32 s94, 0
  s_cbranch_scc1 AS_out
  s_lshl_b32 s36, s24, 11
  s_add_u32 s36, s36, 98304
  s_lshl_b32 s38, s27, 9
  s_add_u32 s38, s38, s36
  v_lshl_add_u32 v9, v1, 3, s38
  ds_write_b64 v9, v[192:193]
  v_lshl_add_u32 v9, v5, 3, s36
  s_waitcnt lgkmcnt(0)
  s_barrier
  ds_read_b64 v[64:65], v9 offset:0
  ds_read_b64 v[66:67], v9 offset:256
  ds_read_b64 v[68:69], v9 offset:512
  ds_read_b64 v[70:71], v9 offset:768
  ds_read_b64 v[72:73], v9 offset:1024
  ds_read_b64 v[74:75], v9 offset:1280
  ds_read_b64 v[76:77], v9 offset:1536
  ds_read_b64 v[78:79], v9 offset:1792
  s_waitcnt lgkmcnt(0)
  v_max3_f32 v192, v64, v66, v192
  v_max3_f32 v192, v68, v70, v192
  v_max3_f32 v192, v72, v74, v192
  v_max3_f32 v192, v76, v78, v192
  v_max3_f32 v193, v65, v67, v193
  v_max3_f32 v193, v69, v71, v193
  v_max3_f32 v193, v73, v75, v193
  v_max3_f32 v193, v77, v79, v193
  s_mov_b32 s94, 1
  s_barrier
  s_branch AS_pass
AS_out:
  ds_write_b128 v240, v[32:35] offset:0
  ds_write_b128 v240, v[36:39] offset:1024
  ds_write_b128 v240, v[40:43] offset:4096
  ds_write_b128 v240, v[44:47] offset:5120
  s_branch A_red2
.section .rodata,"a"
.p2align 6
.amdhsa_kernel concat_heads__mha_block__ssm_conv_s4d__prompt_kernel
  .amdhsa_next_free_vgpr 256
  .amdhsa_next_free_sgpr 102
  .amdhsa_accum_offset 256
  .amdhsa_group_segment_fixed_size 0
  .amdhsa_kernarg_size 104
  .amdhsa_user_sgpr_count 2
  .amdhsa_user_sgpr_kernarg_segment_ptr 1
  .amdhsa_system_sgpr_workgroup_id_x 1
.end_amdhsa_kernel
```
